```python
import torch

def _softmax(x, axis=-1):
    return torch.softmax(x, dim=axis)
def _gelu(x):
    return torch.nn.functional.gelu(x, approximate="tanh")
def _silu(x):
    return torch.nn.functional.silu(x)
def _sigmoid(x):
    return torch.sigmoid(x)
def _layernorm(x, axis=-1, eps=1e-5):
    m = x.mean(dim=axis, keepdim=True)
    v = x.var(dim=axis, keepdim=True, unbiased=False)
    return (x - m) / torch.sqrt(v + eps)
def _scatter_add(tgt, idx, src, axis=0):
    return tgt.clone().index_add_(axis, idx, src)
def _segment_sum(src, seg, n):
    out = torch.zeros((n,) + src.shape[1:], dtype=src.dtype)
    return out.index_add_(0, seg, src)
def _pad(x, pw):
    flat = tuple(v for pair in reversed(pw) for v in pair)
    return torch.nn.functional.pad(x, flat)

kernel_name = 'recurrent_scan__ssm_conv_h3__dense_activation_silu__prompt'

def setup_inputs():

    _w = (lambda a: (lambda t: t.to(torch.bfloat16) if t.is_floating_point() else t)(torch.as_tensor(a)))
    def _A_setup():
        B, S, D = 1, 2048, 576
        ks = 4
        return {
            "q": _w((lambda *s: torch.randn(*s, dtype=torch.bfloat16) * 0.05)(B, S, D)),
            "k": _w((lambda *s: torch.randn(*s, dtype=torch.bfloat16) * 0.8)(B, S, D)),
            "v": _w((lambda *s: torch.randn(*s, dtype=torch.bfloat16) * 0.8)(B, S, D)),
            "shift_k": _w((lambda *s: torch.randn(*s, dtype=torch.bfloat16) * 0.8)(D, ks) * 0.5),
            "ssm_k": _w((lambda *s: torch.randn(*s, dtype=torch.bfloat16) * 0.8)(D, S) * (1.0 / S ** 0.5)),
            "ssm_D": _w((lambda *s: torch.randn(*s, dtype=torch.bfloat16) * 0.8)(D)),
        }
    _A_in = _A_setup()

    def _B_setup():
        B, S, D, F = 1, 2048, 576, 4608
        return {
            "x": _w((lambda *s: torch.randn(*s, dtype=torch.bfloat16) * 0.05)(B, S, D)),
            "w1": _w((lambda *s: torch.randn(*s, dtype=torch.bfloat16) * 0.8)(D, F) * (D ** -0.5)),
            "w2": _w((lambda *s: torch.randn(*s, dtype=torch.bfloat16) * 0.2)(F, D) * (F ** -0.5)),
        }
    _B_in = _B_setup()

    return {
        "A_q": _A_in["q"],
        "A_k": _A_in["k"],
        "A_v": _A_in["v"],
        "A_shift_k": _A_in["shift_k"],
        "A_ssm_k": _A_in["ssm_k"],
        "A_ssm_D": _A_in["ssm_D"],
        "B_x": _B_in["x"],
        "B_w1": _B_in["w1"],
        "B_w2": _B_in["w2"],
    }

def reference(A_q, A_k, A_v, A_shift_k, A_ssm_k, A_ssm_D, B_x, B_w1, B_w2):
    def _A_ref(q, k, v, shift_k, ssm_k, ssm_D):
        B, S, D = q.shape
        ks = shift_k.shape[-1]
        k_pad = _pad(k, ((0, 0), (ks - 1, 0), (0, 0)))
        k_shift = torch.zeros_like(k)
        for t in range(ks):
            k_shift = k_shift + k_pad[:, t:t + S, :] * shift_k[:, ks - 1 - t][None, None, :]
        kv = k_shift * v
        L = 2 * S
        kv_pad = _pad(kv, ((0, 0), (0, S), (0, 0)))
        kf_pad = _pad(ssm_k, ((0, 0), (0, S)))
        kv_f = (lambda x, axes=(-2,-1): torch.fft.rfft2(x.float(), dim=axes))(kv_pad[:, None, :, :], axes=(1, 2))
        kf_f = (lambda x, axes=(-2,-1): torch.fft.rfft2(x.float(), dim=axes))(kf_pad[:, None, :], axes=(1, 2))
        kf_f = (lambda x, *d: x.permute(*d))(kf_f, 1, 2, 0)
        y_f = kv_f * kf_f[None, :, :, :]
        y = (lambda x, s, axes=(-2,-1): torch.fft.irfft2(x, s=s, dim=axes).to(torch.bfloat16))(y_f, (1, L), axes=(1, 2))[:, 0, :S, :]
        y = y + kv * ssm_D[None, None, :]
        return q * y

    def _B_ref(x, w1, w2):
        h = torch.einsum("bsd,df->bsf", x, w1)
        h = _silu(h)
        out = torch.einsum("bsf,fd->bsd", h, w2)
        return out

    x = A_q
    xn = _layernorm(x, axis=-1)
    s = _A_ref(xn, A_k, A_v, A_shift_k, A_ssm_k, A_ssm_D)
    g = _silu(_B_ref(xn, B_w1, B_w2))
    return x + s * g
```

```asm
; @launch kernel=ffn_conv_kernel grid=(256,1,1) block=(256,1,1) lds=163840
; @launch kernel=final_kernel grid=(576,1,1) block=(256,1,1) lds=12800
.amdgcn_target "amdgcn-amd-amdhsa--gfx950"
.text
.globl ffn_conv_kernel
.p2align 8
.type ffn_conv_kernel,@function
ffn_conv_kernel:
  s_cmp_ge_u32 s2, 256
  s_cbranch_scc1 K1_END
  s_load_dwordx8 s[4:11], s[0:1], 0
  s_load_dwordx4 s[12:15], s[0:1], 32
  s_load_dwordx4 s[16:19], s[0:1], 56
  s_load_dwordx4 s[20:23], s[0:1], 80
  s_getpc_b64 s[84:85]
K1_PC:
  s_lshr_b32 s83, s2, 3
  s_min_u32 s82, s83, (K1_END-K1_PC)/1024
  s_lshl_b32 s82, s82, 10
  s_add_u32 s84, s84, s82
  s_addc_u32 s85, s85, 0
  v_lshlrev_b32 v14, 2, v0
  global_load_dword v250, v14, s[84:85]
  s_and_b32 s82, s2, 7
  s_lshr_b32 s83, s2, 3
  s_and_b32 s78, s82, 3
  s_lshl_b32 s78, s78, 1
  s_and_b32 s86, s83, 1
  s_add_u32 s78, s78, s86
  s_lshr_b32 s97, s83, 1
  s_lshr_b32 s77, s82, 2
  s_lshl_b32 s77, s77, 4
  s_add_u32 s77, s77, s97
  v_and_b32 v1, 63, v0
  v_lshrrev_b32 v14, 6, v0
  v_lshrrev_b32 v2, 3, v1
  v_readfirstlane_b32 s74, v14
  v_and_b32 v3, 7, v1
  v_lshrrev_b32 v4, 4, v1
  s_lshl_b32 s79, s74, 11
  s_add_u32 s80, s79, 73728
  s_lshl_b32 s82, s74, 4
  v_add_u32 v5, s82, v2
  v_xor_b32 v6, v3, v4
  v_mul_u32_u24 v7, 1152, v5
  v_lshl_add_u32 v72, v6, 4, v7
  v_xor_b32 v6, 4, v6
  v_lshl_add_u32 v73, v6, 4, v7
  v_add_u32 v73, 8192, v73
  s_mul_i32 s86, s77, 73728
  s_waitcnt lgkmcnt(0)
  s_mov_b32 s24, s4
  s_mov_b32 s25, s5
  s_mov_b32 s26, 2359296
  s_mov_b32 s27, 0x00020000
  s_add_u32 m0, s80, 0
  s_nop 0
  buffer_load_dwordx4 v72, s[24:27], s86 offen lds
  buffer_load_dwordx4 v73, s[24:27], s86 offen offset:1024 lds
  s_add_u32 m0, s80, 8192
  s_add_u32 s86, s86, 128
  buffer_load_dwordx4 v72, s[24:27], s86 offen lds
  buffer_load_dwordx4 v73, s[24:27], s86 offen offset:1024 lds
  s_add_u32 m0, s80, 16384
  s_add_u32 s86, s86, 128
  buffer_load_dwordx4 v72, s[24:27], s86 offen lds
  buffer_load_dwordx4 v73, s[24:27], s86 offen offset:1024 lds
  s_add_u32 m0, s80, 24576
  s_add_u32 s86, s86, 128
  buffer_load_dwordx4 v72, s[24:27], s86 offen lds
  buffer_load_dwordx4 v73, s[24:27], s86 offen offset:1024 lds
  s_add_u32 m0, s80, 32768
  s_add_u32 s86, s86, 128
  buffer_load_dwordx4 v72, s[24:27], s86 offen lds
  buffer_load_dwordx4 v73, s[24:27], s86 offen offset:1024 lds
  s_add_u32 m0, s80, 40960
  s_add_u32 s86, s86, 128
  buffer_load_dwordx4 v72, s[24:27], s86 offen lds
  buffer_load_dwordx4 v73, s[24:27], s86 offen offset:1024 lds
  s_add_u32 m0, s80, 49152
  s_add_u32 s86, s86, 128
  buffer_load_dwordx4 v72, s[24:27], s86 offen lds
  buffer_load_dwordx4 v73, s[24:27], s86 offen offset:1024 lds
  s_add_u32 m0, s80, 57344
  s_add_u32 s86, s86, 128
  buffer_load_dwordx4 v72, s[24:27], s86 offen lds
  buffer_load_dwordx4 v73, s[24:27], s86 offen offset:1024 lds
  s_add_u32 m0, s80, 65536
  s_add_u32 s86, s86, 128
  buffer_load_dwordx4 v72, s[24:27], s86 offen lds
  buffer_load_dwordx4 v73, s[24:27], s86 offen offset:1024 lds
  s_mov_b32 s28, s16
  s_mov_b32 s29, s17
  s_mov_b32 s30, 5308416
  s_mov_b32 s31, 0x00020000
  s_mov_b32 s32, s18
  s_mov_b32 s33, s19
  s_mov_b32 s34, 5308416
  s_mov_b32 s35, 0x00020000
  s_or_b32 s82, s2, s74
  s_cmp_lg_u32 s82, 0
  s_cbranch_scc1 K1_NONONCE
  s_memrealtime s[90:91]
  s_waitcnt lgkmcnt(0)
  s_or_b32 s90, s90, 1
  v_mov_b32 v248, 0
  v_mov_b32 v249, s90
  s_mov_b64 exec, 1
  global_store_dword v248, v249, s[20:21] sc1
  s_mov_b64 exec, -1
K1_NONONCE:
  v_mov_b32 v9, 0x80000000
  s_lshl_b32 s87, s97, 2
  s_add_u32 s87, s87, s74
  s_mul_i32 s87, s87, 9
  v_mul_u32_u24 v243, 7282, v1
  v_lshrrev_b32 v243, 16, v243
  v_mul_u32_u24 v6, 9, v243
  v_sub_u32 v6, v1, v6
  v_add_u32 v6, s87, v6
  s_movk_i32 s87, 9216
  v_mul_lo_u32 v238, v6, s87
  v_lshl_add_u32 v238, v243, 7, v238
  s_mul_i32 s83, s78, 1152
  v_add_u32 v238, s83, v238
  v_mul_u32_u24 v8, 7282, v6
  v_lshrrev_b32 v8, 16, v8
  v_mul_u32_u24 v14, 9, v8
  v_sub_u32 v6, v6, v14
  v_lshl_add_u32 v8, v243, 6, v8
  v_mul_u32_u24 v8, 1152, v8
  v_lshl_add_u32 v8, v6, 7, v8
  s_mul_i32 s82, s78, 663552
  v_add_u32 v239, s82, v8
  v_cmp_gt_u32 vcc, 1, v243
  s_nop 1
  v_cndmask_b32 v5, v9, v238, vcc
  buffer_load_dword v249, v5, s[28:31], 0 offen
  v_subrev_u32 v246, 1, v243
  v_cmp_gt_u32 vcc, 2, v246
  s_nop 1
  v_cndmask_b32 v246, v9, v238, vcc
  v_cmp_gt_u32 vcc, 2, v243
  s_nop 1
  v_cndmask_b32 v247, v9, v239, vcc
  s_mov_b32 s98, 0xffff0000
  s_lshl_b32 s82, s2, 2
  s_add_u32 s82, s82, s74
  s_min_u32 s82, s82, 575
  s_lshl_b32 s82, s82, 1
  s_and_b32 s82, s82, 0xfffffffc
  s_load_dword s99, s[14:15], s82
  s_lshr_b32 s75, s74, 1
  s_and_b32 s76, s74, 1
  v_and_b32 v6, 1, v4
  v_lshlrev_b32 v6, 2, v6
  v_xor_b32 v6, v3, v6
  v_lshlrev_b32 v6, 4, v6
  v_xor_b32 v8, 0, v6
  s_mul_i32 s82, s78, 663552
  v_add3_u32 v12, v7, v6, s82
  v_add3_u32 v13, v7, v8, s82
  v_add_u32 v13, 8192, v13
  s_mul_i32 s83, s78, 1152
  v_lshlrev_b32 v7, 3, v7
  v_add3_u32 v10, v7, v6, s83
  v_add3_u32 v11, v7, v8, s83
  v_add_u32 v11, 72704, v11
  s_mov_b32 s56, 0
  s_mov_b32 s65, 0
  s_mov_b32 s57, 589824
  s_mov_b32 s66, 128
  s_mov_b32 s58, 1179648
  s_mov_b32 s67, 256
  s_mov_b32 s59, 1769472
  s_mov_b32 s68, 384
  s_mov_b32 s60, 2359296
  s_mov_b32 s69, 512
  s_mov_b32 s61, 2949120
  s_mov_b32 s70, 640
  s_mov_b32 s62, 3538944
  s_mov_b32 s71, 768
  s_mov_b32 s63, 4128768
  s_mov_b32 s72, 896
  s_mov_b32 s64, 4718592
  s_mov_b32 s73, 1024
  v_add_u32 v238, 384, v238
  v_add_u32 v239, 147456, v239
  v_cmp_gt_u32 vcc, 1, v243
  s_nop 1
  v_cndmask_b32 v238, v9, v238, vcc
  v_cndmask_b32 v239, v9, v239, vcc
  s_mov_b32 s40, s6
  s_mov_b32 s41, s7
  s_mov_b32 s42, 2359296
  s_mov_b32 s43, 0x00020000
  s_mov_b32 s44, s8
  s_mov_b32 s45, s9
  s_mov_b32 s46, 2359296
  s_mov_b32 s47, 0x00020000
  s_mov_b32 s48, s10
  s_mov_b32 s49, s11
  s_mov_b32 s50, 4608
  s_mov_b32 s51, 0x00020000
  s_lshl_b32 s82, s74, 6
  v_add_u32 v5, s82, v1
  s_mul_i32 s83, s77, 73728
  s_mul_i32 s82, s78, 144
  s_add_u32 s94, s83, s82
  s_sub_u32 s87, s94, 3456
  s_movk_i32 s82, 7282
  v_mul_lo_u32 v6, v5, s82
  v_lshrrev_b32 v6, 16, v6
  v_mul_u32_u24 v7, 9, v6
  v_sub_u32 v7, v5, v7
  v_mul_u32_u24 v8, 1152, v6
  v_lshl_add_u32 v8, v7, 4, v8
  v_cmp_gt_u32 vcc, 64, v6
  v_add_u32 v7, s87, v8
  s_nop 0
  v_cndmask_b32 v231, v9, v8, vcc
  v_cmp_gt_u32 vcc, 67, v6
  v_cmp_le_i32 s[90:91], 0, v7
  s_and_b64 vcc, vcc, s[90:91]
  v_cndmask_b32 v228, v9, v7, vcc
  v_add_u32 v5, 256, v5
  v_mul_lo_u32 v6, v5, s82
  v_lshrrev_b32 v6, 16, v6
  v_mul_u32_u24 v7, 9, v6
  v_sub_u32 v7, v5, v7
  v_mul_u32_u24 v8, 1152, v6
  v_lshl_add_u32 v8, v7, 4, v8
  v_cmp_gt_u32 vcc, 64, v6
  v_add_u32 v7, s87, v8
  s_nop 0
  v_cndmask_b32 v232, v9, v8, vcc
  v_cmp_gt_u32 vcc, 67, v6
  v_cmp_le_i32 s[90:91], 0, v7
  s_and_b64 vcc, vcc, s[90:91]
  v_cndmask_b32 v229, v9, v7, vcc
  v_add_u32 v5, 256, v5
  v_mul_lo_u32 v6, v5, s82
  v_lshrrev_b32 v6, 16, v6
  v_mul_u32_u24 v7, 9, v6
  v_sub_u32 v7, v5, v7
  v_mul_u32_u24 v8, 1152, v6
  v_lshl_add_u32 v8, v7, 4, v8
  v_cmp_gt_u32 vcc, 64, v6
  v_add_u32 v7, s87, v8
  s_nop 0
  v_cndmask_b32 v233, v9, v8, vcc
  v_cmp_gt_u32 vcc, 67, v6
  v_cmp_le_i32 s[90:91], 0, v7
  s_and_b64 vcc, vcc, s[90:91]
  v_cndmask_b32 v230, v9, v7, vcc
  s_lshl_b32 s82, s74, 10
  s_add_u32 s95, s82, 122880
  v_lshrrev_b32 v5, 1, v0
  v_and_b32 v6, 1, v0
  v_mul_u32_u24 v6, 140, v6
  v_mul_u32_u24 v7, 1152, v5
  v_add_u32 v6, v6, v7
  v_cmp_gt_u32 vcc, 64, v5
  v_add_u32 v7, s87, v6
  s_nop 0
  v_cndmask_b32 v245, v9, v6, vcc
  v_cmp_gt_u32 vcc, 67, v5
  v_cmp_le_i32 s[90:91], 0, v7
  s_and_b64 vcc, vcc, s[90:91]
  v_cndmask_b32 v244, v9, v7, vcc
  buffer_load_dword v249, v244, s[40:43], 0 offen
  s_mul_i32 s82, s74, 36
  v_add_u32 v5, s82, v1
  v_lshrrev_b32 v6, 3, v5
  s_mul_i32 s83, s78, 72
  v_lshl_add_u32 v234, v6, 2, s83
  v_and_b32 v235, 7, v5
  v_lshlrev_b32 v7, 3, v234
  v_cmp_gt_u32 vcc, 36, v1
  v_mul_u32_u24 v8, 1152, v235
  v_lshl_add_u32 v8, v6, 3, v8
  v_cndmask_b32 v242, v9, v7, vcc
  v_add_u32 v241, 122880, v8
  s_mov_b32 s36, s22
  s_mov_b32 s37, s23
  s_mov_b32 s38, 268435456
  s_mov_b32 s39, 0x00020000
  s_mov_b32 s52, s12
  s_mov_b32 s53, s13
  s_mov_b32 s54, 2359296
  s_mov_b32 s55, 0x00020000
  s_movk_i32 s82, 4112
  v_mul_lo_u32 v7, v234, s82
  s_lshl_b32 s82, s77, 7
  v_lshlrev_b32 v8, 4, v235
  v_add_u32 v8, s82, v8
  v_sub_u32 v7, v7, v8
  v_add_u32 v7, 20975600, v7
  v_cmp_gt_u32 vcc, 36, v1
  s_nop 1
  v_cndmask_b32 v236, v9, v7, vcc
  v_lshrrev_b32 v2, 2, v1
  s_lshl_b32 s82, s74, 4
  v_add_u32 v2, s82, v2
  v_bfe_u32 v3, v2, 1, 3
  v_and_b32 v4, 3, v1
  v_xor_b32 v3, v3, v4
  v_lshlrev_b32 v3, 4, v3
  v_lshl_add_u32 v3, v2, 7, v3
  v_add_u32 v76, 73728, v3
  v_xor_b32 v77, 64, v76
  v_add_u32 v78, 32768, v76
  v_add_u32 v79, 32768, v77
  v_mov_b32 v64, 0x3f803f80
  v_mov_b32 v66, 0
  v_mov_b32 v67, 0
  v_mov_b32 v68, 0
  v_mov_b32 v69, 0
  v_mov_b32 v48, 0
  v_mov_b32 v49, 0
  v_mov_b32 v50, 0
  v_mov_b32 v51, 0
  s_waitcnt vmcnt(18)
  ds_read_b128 v[152:155], v76 offset:0
  ds_read_b128 v[156:159], v77 offset:0
  s_waitcnt vmcnt(16)
  ds_read_b128 v[160:163], v76 offset:8192
  ds_read_b128 v[164:167], v77 offset:8192
  s_waitcnt lgkmcnt(2)
  v_dot2c_f32_bf16 v66, v152, v64
  v_dot2c_f32_bf16 v48, v152, v152
  v_dot2c_f32_bf16 v67, v153, v64
  v_dot2c_f32_bf16 v49, v153, v153
  v_dot2c_f32_bf16 v68, v154, v64
  v_dot2c_f32_bf16 v50, v154, v154
  v_dot2c_f32_bf16 v69, v155, v64
  v_dot2c_f32_bf16 v51, v155, v155
  v_dot2c_f32_bf16 v66, v156, v64
  v_dot2c_f32_bf16 v48, v156, v156
  v_dot2c_f32_bf16 v67, v157, v64
  v_dot2c_f32_bf16 v49, v157, v157
  v_dot2c_f32_bf16 v68, v158, v64
  v_dot2c_f32_bf16 v50, v158, v158
  v_dot2c_f32_bf16 v69, v159, v64
  v_dot2c_f32_bf16 v51, v159, v159
  s_waitcnt vmcnt(14)
  ds_read_b128 v[168:171], v76 offset:16384
  ds_read_b128 v[172:175], v77 offset:16384
  s_waitcnt lgkmcnt(2)
  v_dot2c_f32_bf16 v66, v160, v64
  v_dot2c_f32_bf16 v48, v160, v160
  v_dot2c_f32_bf16 v67, v161, v64
  v_dot2c_f32_bf16 v49, v161, v161
  v_dot2c_f32_bf16 v68, v162, v64
  v_dot2c_f32_bf16 v50, v162, v162
  v_dot2c_f32_bf16 v69, v163, v64
  v_dot2c_f32_bf16 v51, v163, v163
  v_dot2c_f32_bf16 v66, v164, v64
  v_dot2c_f32_bf16 v48, v164, v164
  v_dot2c_f32_bf16 v67, v165, v64
  v_dot2c_f32_bf16 v49, v165, v165
  v_dot2c_f32_bf16 v68, v166, v64
  v_dot2c_f32_bf16 v50, v166, v166
  v_dot2c_f32_bf16 v69, v167, v64
  v_dot2c_f32_bf16 v51, v167, v167
  s_waitcnt vmcnt(12)
  ds_read_b128 v[176:179], v76 offset:24576
  ds_read_b128 v[180:183], v77 offset:24576
  s_waitcnt lgkmcnt(2)
  v_dot2c_f32_bf16 v66, v168, v64
  v_dot2c_f32_bf16 v48, v168, v168
  v_dot2c_f32_bf16 v67, v169, v64
  v_dot2c_f32_bf16 v49, v169, v169
  v_dot2c_f32_bf16 v68, v170, v64
  v_dot2c_f32_bf16 v50, v170, v170
  v_dot2c_f32_bf16 v69, v171, v64
  v_dot2c_f32_bf16 v51, v171, v171
  v_dot2c_f32_bf16 v66, v172, v64
  v_dot2c_f32_bf16 v48, v172, v172
  v_dot2c_f32_bf16 v67, v173, v64
  v_dot2c_f32_bf16 v49, v173, v173
  v_dot2c_f32_bf16 v68, v174, v64
  v_dot2c_f32_bf16 v50, v174, v174
  v_dot2c_f32_bf16 v69, v175, v64
  v_dot2c_f32_bf16 v51, v175, v175
  s_waitcnt vmcnt(10)
  ds_read_b128 v[184:187], v78 offset:0
  ds_read_b128 v[188:191], v79 offset:0
  s_waitcnt lgkmcnt(2)
  v_dot2c_f32_bf16 v66, v176, v64
  v_dot2c_f32_bf16 v48, v176, v176
  v_dot2c_f32_bf16 v67, v177, v64
  v_dot2c_f32_bf16 v49, v177, v177
  v_dot2c_f32_bf16 v68, v178, v64
  v_dot2c_f32_bf16 v50, v178, v178
  v_dot2c_f32_bf16 v69, v179, v64
  v_dot2c_f32_bf16 v51, v179, v179
  v_dot2c_f32_bf16 v66, v180, v64
  v_dot2c_f32_bf16 v48, v180, v180
  v_dot2c_f32_bf16 v67, v181, v64
  v_dot2c_f32_bf16 v49, v181, v181
  v_dot2c_f32_bf16 v68, v182, v64
  v_dot2c_f32_bf16 v50, v182, v182
  v_dot2c_f32_bf16 v69, v183, v64
  v_dot2c_f32_bf16 v51, v183, v183
  s_waitcnt vmcnt(8)
  ds_read_b128 v[192:195], v78 offset:8192
  ds_read_b128 v[196:199], v79 offset:8192
  s_waitcnt lgkmcnt(2)
  v_dot2c_f32_bf16 v66, v184, v64
  v_dot2c_f32_bf16 v48, v184, v184
  v_dot2c_f32_bf16 v67, v185, v64
  v_dot2c_f32_bf16 v49, v185, v185
  v_dot2c_f32_bf16 v68, v186, v64
  v_dot2c_f32_bf16 v50, v186, v186
  v_dot2c_f32_bf16 v69, v187, v64
  v_dot2c_f32_bf16 v51, v187, v187
  v_dot2c_f32_bf16 v66, v188, v64
  v_dot2c_f32_bf16 v48, v188, v188
  v_dot2c_f32_bf16 v67, v189, v64
  v_dot2c_f32_bf16 v49, v189, v189
  v_dot2c_f32_bf16 v68, v190, v64
  v_dot2c_f32_bf16 v50, v190, v190
  v_dot2c_f32_bf16 v69, v191, v64
  v_dot2c_f32_bf16 v51, v191, v191
  s_waitcnt vmcnt(6)
  ds_read_b128 v[200:203], v78 offset:16384
  ds_read_b128 v[204:207], v79 offset:16384
  s_waitcnt lgkmcnt(2)
  v_dot2c_f32_bf16 v66, v192, v64
  v_dot2c_f32_bf16 v48, v192, v192
  v_dot2c_f32_bf16 v67, v193, v64
  v_dot2c_f32_bf16 v49, v193, v193
  v_dot2c_f32_bf16 v68, v194, v64
  v_dot2c_f32_bf16 v50, v194, v194
  v_dot2c_f32_bf16 v69, v195, v64
  v_dot2c_f32_bf16 v51, v195, v195
  v_dot2c_f32_bf16 v66, v196, v64
  v_dot2c_f32_bf16 v48, v196, v196
  v_dot2c_f32_bf16 v67, v197, v64
  v_dot2c_f32_bf16 v49, v197, v197
  v_dot2c_f32_bf16 v68, v198, v64
  v_dot2c_f32_bf16 v50, v198, v198
  v_dot2c_f32_bf16 v69, v199, v64
  v_dot2c_f32_bf16 v51, v199, v199
  s_waitcnt vmcnt(4)
  ds_read_b128 v[208:211], v78 offset:24576
  ds_read_b128 v[212:215], v79 offset:24576
  s_waitcnt lgkmcnt(2)
  v_dot2c_f32_bf16 v66, v200, v64
  v_dot2c_f32_bf16 v48, v200, v200
  v_dot2c_f32_bf16 v67, v201, v64
  v_dot2c_f32_bf16 v49, v201, v201
  v_dot2c_f32_bf16 v68, v202, v64
  v_dot2c_f32_bf16 v50, v202, v202
  v_dot2c_f32_bf16 v69, v203, v64
  v_dot2c_f32_bf16 v51, v203, v203
  v_dot2c_f32_bf16 v66, v204, v64
  v_dot2c_f32_bf16 v48, v204, v204
  v_dot2c_f32_bf16 v67, v205, v64
  v_dot2c_f32_bf16 v49, v205, v205
  v_dot2c_f32_bf16 v68, v206, v64
  v_dot2c_f32_bf16 v50, v206, v206
  v_dot2c_f32_bf16 v69, v207, v64
  v_dot2c_f32_bf16 v51, v207, v207
  s_waitcnt vmcnt(2)
  ds_read_b128 v[216:219], v78 offset:32768
  ds_read_b128 v[220:223], v79 offset:32768
  s_waitcnt lgkmcnt(2)
  v_dot2c_f32_bf16 v66, v208, v64
  v_dot2c_f32_bf16 v48, v208, v208
  v_dot2c_f32_bf16 v67, v209, v64
  v_dot2c_f32_bf16 v49, v209, v209
  v_dot2c_f32_bf16 v68, v210, v64
  v_dot2c_f32_bf16 v50, v210, v210
  v_dot2c_f32_bf16 v69, v211, v64
  v_dot2c_f32_bf16 v51, v211, v211
  v_dot2c_f32_bf16 v66, v212, v64
  v_dot2c_f32_bf16 v48, v212, v212
  v_dot2c_f32_bf16 v67, v213, v64
  v_dot2c_f32_bf16 v49, v213, v213
  v_dot2c_f32_bf16 v68, v214, v64
  v_dot2c_f32_bf16 v50, v214, v214
  v_dot2c_f32_bf16 v69, v215, v64
  v_dot2c_f32_bf16 v51, v215, v215
  s_waitcnt lgkmcnt(0)
  v_dot2c_f32_bf16 v66, v216, v64
  v_dot2c_f32_bf16 v48, v216, v216
  v_dot2c_f32_bf16 v67, v217, v64
  v_dot2c_f32_bf16 v49, v217, v217
  v_dot2c_f32_bf16 v68, v218, v64
  v_dot2c_f32_bf16 v50, v218, v218
  v_dot2c_f32_bf16 v69, v219, v64
  v_dot2c_f32_bf16 v51, v219, v219
  v_dot2c_f32_bf16 v66, v220, v64
  v_dot2c_f32_bf16 v48, v220, v220
  v_dot2c_f32_bf16 v67, v221, v64
  v_dot2c_f32_bf16 v49, v221, v221
  v_dot2c_f32_bf16 v68, v222, v64
  v_dot2c_f32_bf16 v50, v222, v222
  v_dot2c_f32_bf16 v69, v223, v64
  v_dot2c_f32_bf16 v51, v223, v223
  s_nop 3
  v_add_f32 v66, v66, v67
  v_add_f32 v68, v68, v69
  v_add_f32 v66, v66, v68
  s_nop 1
  v_add_f32_dpp v66, v66, v66 quad_perm:[1,0,3,2] row_mask:0xf bank_mask:0xf
  s_nop 1
  v_add_f32_dpp v66, v66, v66 quad_perm:[2,3,0,1] row_mask:0xf bank_mask:0xf
  v_mul_f32 v70, 0x3ae38e39, v66
  v_mov_b32 v66, v48
  v_mov_b32 v67, v49
  v_mov_b32 v68, v50
  v_mov_b32 v69, v51
  v_add_f32 v66, v66, v67
  v_add_f32 v68, v68, v69
  v_add_f32 v66, v66, v68
  s_nop 1
  v_add_f32_dpp v66, v66, v66 quad_perm:[1,0,3,2] row_mask:0xf bank_mask:0xf
  s_nop 1
  v_add_f32_dpp v66, v66, v66 quad_perm:[2,3,0,1] row_mask:0xf bank_mask:0xf
  v_mul_f32 v67, 0x3ae38e39, v66
  v_fma_f32 v67, -v70, v70, v67
  v_max_f32 v67, 0, v67
  v_add_f32 v67, 0x3727c5ac, v67
  v_rsq_f32 v67, v67
  v_mov_b32 v66, v70
  v_mul_f32 v68, 0xbfb8aa3b, v67
  v_mov_b32 v69, v68
  v_mul_f32 v64, v70, v68
  v_sub_f32 v64, 0, v64
  v_mov_b32 v65, v64
  v_lshlrev_b32 v80, 16, v152
  v_and_b32 v81, s98, v152
  v_lshlrev_b32 v82, 16, v153
  v_and_b32 v83, s98, v153
  v_lshlrev_b32 v84, 16, v154
  v_and_b32 v85, s98, v154
  v_lshlrev_b32 v86, 16, v155
  v_and_b32 v87, s98, v155
  v_pk_fma_f32 v[80:81], v[80:81], v[68:69], v[64:65]
  v_pk_fma_f32 v[82:83], v[82:83], v[68:69], v[64:65]
  v_pk_fma_f32 v[84:85], v[84:85], v[68:69], v[64:65]
  v_pk_fma_f32 v[86:87], v[86:87], v[68:69], v[64:65]
  v_cvt_pk_bf16_f32 v96, v80, v81
  v_cvt_pk_bf16_f32 v97, v82, v83
  v_cvt_pk_bf16_f32 v98, v84, v85
  v_cvt_pk_bf16_f32 v99, v86, v87
  ds_write_b128 v76, v[96:99] offset:0
  s_add_u32 m0, s79, 0
  s_nop 0
  buffer_load_dwordx4 v10, s[28:31], s56 offen lds
  buffer_load_dwordx4 v11, s[28:31], s56 offen offset:1024 lds
  v_lshlrev_b32 v88, 16, v156
  v_and_b32 v89, s98, v156
  v_lshlrev_b32 v90, 16, v157
  v_and_b32 v91, s98, v157
  v_lshlrev_b32 v92, 16, v158
  v_and_b32 v93, s98, v158
  v_lshlrev_b32 v94, 16, v159
  v_and_b32 v95, s98, v159
  v_pk_fma_f32 v[88:89], v[88:89], v[68:69], v[64:65]
  v_pk_fma_f32 v[90:91], v[90:91], v[68:69], v[64:65]
  v_pk_fma_f32 v[92:93], v[92:93], v[68:69], v[64:65]
  v_pk_fma_f32 v[94:95], v[94:95], v[68:69], v[64:65]
  v_cvt_pk_bf16_f32 v100, v88, v89
  v_cvt_pk_bf16_f32 v101, v90, v91
  v_cvt_pk_bf16_f32 v102, v92, v93
  v_cvt_pk_bf16_f32 v103, v94, v95
  ds_write_b128 v77, v[100:103] offset:0
  s_add_u32 m0, s79, 8192
  s_nop 0
  buffer_load_dwordx4 v10, s[28:31], s57 offen lds
  v_lshlrev_b32 v80, 16, v160
  v_and_b32 v81, s98, v160
  v_lshlrev_b32 v82, 16, v161
  v_and_b32 v83, s98, v161
  v_lshlrev_b32 v84, 16, v162
  v_and_b32 v85, s98, v162
  v_lshlrev_b32 v86, 16, v163
  v_and_b32 v87, s98, v163
  v_pk_fma_f32 v[80:81], v[80:81], v[68:69], v[64:65]
  v_pk_fma_f32 v[82:83], v[82:83], v[68:69], v[64:65]
  v_pk_fma_f32 v[84:85], v[84:85], v[68:69], v[64:65]
  v_pk_fma_f32 v[86:87], v[86:87], v[68:69], v[64:65]
  v_cvt_pk_bf16_f32 v104, v80, v81
  v_cvt_pk_bf16_f32 v105, v82, v83
  v_cvt_pk_bf16_f32 v106, v84, v85
  v_cvt_pk_bf16_f32 v107, v86, v87
  ds_write_b128 v76, v[104:107] offset:8192
  buffer_load_dwordx4 v11, s[28:31], s57 offen offset:1024 lds
  v_lshlrev_b32 v88, 16, v164
  v_and_b32 v89, s98, v164
  v_lshlrev_b32 v90, 16, v165
  v_and_b32 v91, s98, v165
  v_lshlrev_b32 v92, 16, v166
  v_and_b32 v93, s98, v166
  v_lshlrev_b32 v94, 16, v167
  v_and_b32 v95, s98, v167
  v_pk_fma_f32 v[88:89], v[88:89], v[68:69], v[64:65]
  v_pk_fma_f32 v[90:91], v[90:91], v[68:69], v[64:65]
  v_pk_fma_f32 v[92:93], v[92:93], v[68:69], v[64:65]
  v_pk_fma_f32 v[94:95], v[94:95], v[68:69], v[64:65]
  v_cvt_pk_bf16_f32 v108, v88, v89
  v_cvt_pk_bf16_f32 v109, v90, v91
  v_cvt_pk_bf16_f32 v110, v92, v93
  v_cvt_pk_bf16_f32 v111, v94, v95
  ds_write_b128 v77, v[108:111] offset:8192
  s_add_u32 m0, s79, 16384
  s_nop 0
  buffer_load_dwordx4 v10, s[28:31], s58 offen lds
  buffer_load_dwordx4 v11, s[28:31], s58 offen offset:1024 lds
  v_lshlrev_b32 v80, 16, v168
  v_and_b32 v81, s98, v168
  v_lshlrev_b32 v82, 16, v169
  v_and_b32 v83, s98, v169
  v_lshlrev_b32 v84, 16, v170
  v_and_b32 v85, s98, v170
  v_lshlrev_b32 v86, 16, v171
  v_and_b32 v87, s98, v171
  v_pk_fma_f32 v[80:81], v[80:81], v[68:69], v[64:65]
  v_pk_fma_f32 v[82:83], v[82:83], v[68:69], v[64:65]
  v_pk_fma_f32 v[84:85], v[84:85], v[68:69], v[64:65]
  v_pk_fma_f32 v[86:87], v[86:87], v[68:69], v[64:65]
  v_cvt_pk_bf16_f32 v96, v80, v81
  v_cvt_pk_bf16_f32 v97, v82, v83
  v_cvt_pk_bf16_f32 v98, v84, v85
  v_cvt_pk_bf16_f32 v99, v86, v87
  ds_write_b128 v76, v[96:99] offset:16384
  s_add_u32 m0, s79, 24576
  s_nop 0
  buffer_load_dwordx4 v10, s[28:31], s59 offen lds
  v_lshlrev_b32 v88, 16, v172
  v_and_b32 v89, s98, v172
  v_lshlrev_b32 v90, 16, v173
  v_and_b32 v91, s98, v173
  v_lshlrev_b32 v92, 16, v174
  v_and_b32 v93, s98, v174
  v_lshlrev_b32 v94, 16, v175
  v_and_b32 v95, s98, v175
  v_pk_fma_f32 v[88:89], v[88:89], v[68:69], v[64:65]
  v_pk_fma_f32 v[90:91], v[90:91], v[68:69], v[64:65]
  v_pk_fma_f32 v[92:93], v[92:93], v[68:69], v[64:65]
  v_pk_fma_f32 v[94:95], v[94:95], v[68:69], v[64:65]
  v_cvt_pk_bf16_f32 v100, v88, v89
  v_cvt_pk_bf16_f32 v101, v90, v91
  v_cvt_pk_bf16_f32 v102, v92, v93
  v_cvt_pk_bf16_f32 v103, v94, v95
  ds_write_b128 v77, v[100:103] offset:16384
  buffer_load_dwordx4 v11, s[28:31], s59 offen offset:1024 lds
  v_lshlrev_b32 v80, 16, v176
  v_and_b32 v81, s98, v176
  v_lshlrev_b32 v82, 16, v177
  v_and_b32 v83, s98, v177
  v_lshlrev_b32 v84, 16, v178
  v_and_b32 v85, s98, v178
  v_lshlrev_b32 v86, 16, v179
  v_and_b32 v87, s98, v179
  v_pk_fma_f32 v[80:81], v[80:81], v[68:69], v[64:65]
  v_pk_fma_f32 v[82:83], v[82:83], v[68:69], v[64:65]
  v_pk_fma_f32 v[84:85], v[84:85], v[68:69], v[64:65]
  v_pk_fma_f32 v[86:87], v[86:87], v[68:69], v[64:65]
  v_cvt_pk_bf16_f32 v104, v80, v81
  v_cvt_pk_bf16_f32 v105, v82, v83
  v_cvt_pk_bf16_f32 v106, v84, v85
  v_cvt_pk_bf16_f32 v107, v86, v87
  ds_write_b128 v76, v[104:107] offset:24576
  buffer_load_dword v249, v245, s[44:47], s94 offen
  v_lshlrev_b32 v88, 16, v180
  v_and_b32 v89, s98, v180
  v_lshlrev_b32 v90, 16, v181
  v_and_b32 v91, s98, v181
  v_lshlrev_b32 v92, 16, v182
  v_and_b32 v93, s98, v182
  v_lshlrev_b32 v94, 16, v183
  v_and_b32 v95, s98, v183
  v_pk_fma_f32 v[88:89], v[88:89], v[68:69], v[64:65]
  v_pk_fma_f32 v[90:91], v[90:91], v[68:69], v[64:65]
  v_pk_fma_f32 v[92:93], v[92:93], v[68:69], v[64:65]
  v_pk_fma_f32 v[94:95], v[94:95], v[68:69], v[64:65]
  v_cvt_pk_bf16_f32 v108, v88, v89
  v_cvt_pk_bf16_f32 v109, v90, v91
  v_cvt_pk_bf16_f32 v110, v92, v93
  v_cvt_pk_bf16_f32 v111, v94, v95
  ds_write_b128 v77, v[108:111] offset:24576
  s_add_u32 m0, s79, 32768
  s_nop 0
  buffer_load_dwordx4 v10, s[28:31], s60 offen lds
  buffer_load_dwordx4 v11, s[28:31], s60 offen offset:1024 lds
  v_lshlrev_b32 v80, 16, v184
  v_and_b32 v81, s98, v184
  v_lshlrev_b32 v82, 16, v185
  v_and_b32 v83, s98, v185
  v_lshlrev_b32 v84, 16, v186
  v_and_b32 v85, s98, v186
  v_lshlrev_b32 v86, 16, v187
  v_and_b32 v87, s98, v187
  v_pk_fma_f32 v[80:81], v[80:81], v[68:69], v[64:65]
  v_pk_fma_f32 v[82:83], v[82:83], v[68:69], v[64:65]
  v_pk_fma_f32 v[84:85], v[84:85], v[68:69], v[64:65]
  v_pk_fma_f32 v[86:87], v[86:87], v[68:69], v[64:65]
  v_cvt_pk_bf16_f32 v96, v80, v81
  v_cvt_pk_bf16_f32 v97, v82, v83
  v_cvt_pk_bf16_f32 v98, v84, v85
  v_cvt_pk_bf16_f32 v99, v86, v87
  ds_write_b128 v78, v[96:99] offset:0
  s_add_u32 m0, s79, 40960
  s_nop 0
  buffer_load_dwordx4 v10, s[28:31], s61 offen lds
  v_lshlrev_b32 v88, 16, v188
  v_and_b32 v89, s98, v188
  v_lshlrev_b32 v90, 16, v189
  v_and_b32 v91, s98, v189
  v_lshlrev_b32 v92, 16, v190
  v_and_b32 v93, s98, v190
  v_lshlrev_b32 v94, 16, v191
  v_and_b32 v95, s98, v191
  v_pk_fma_f32 v[88:89], v[88:89], v[68:69], v[64:65]
  v_pk_fma_f32 v[90:91], v[90:91], v[68:69], v[64:65]
  v_pk_fma_f32 v[92:93], v[92:93], v[68:69], v[64:65]
  v_pk_fma_f32 v[94:95], v[94:95], v[68:69], v[64:65]
  v_cvt_pk_bf16_f32 v100, v88, v89
  v_cvt_pk_bf16_f32 v101, v90, v91
  v_cvt_pk_bf16_f32 v102, v92, v93
  v_cvt_pk_bf16_f32 v103, v94, v95
  ds_write_b128 v79, v[100:103] offset:0
  buffer_load_dwordx4 v11, s[28:31], s61 offen offset:1024 lds
  v_lshlrev_b32 v80, 16, v192
  v_and_b32 v81, s98, v192
  v_lshlrev_b32 v82, 16, v193
  v_and_b32 v83, s98, v193
  v_lshlrev_b32 v84, 16, v194
  v_and_b32 v85, s98, v194
  v_lshlrev_b32 v86, 16, v195
  v_and_b32 v87, s98, v195
  v_pk_fma_f32 v[80:81], v[80:81], v[68:69], v[64:65]
  v_pk_fma_f32 v[82:83], v[82:83], v[68:69], v[64:65]
  v_pk_fma_f32 v[84:85], v[84:85], v[68:69], v[64:65]
  v_pk_fma_f32 v[86:87], v[86:87], v[68:69], v[64:65]
  v_cvt_pk_bf16_f32 v104, v80, v81
  v_cvt_pk_bf16_f32 v105, v82, v83
  v_cvt_pk_bf16_f32 v106, v84, v85
  v_cvt_pk_bf16_f32 v107, v86, v87
  ds_write_b128 v78, v[104:107] offset:8192
  s_add_u32 m0, s79, 49152
  s_nop 0
  buffer_load_dwordx4 v10, s[28:31], s62 offen lds
  buffer_load_dwordx4 v11, s[28:31], s62 offen offset:1024 lds
  v_lshlrev_b32 v88, 16, v196
  v_and_b32 v89, s98, v196
  v_lshlrev_b32 v90, 16, v197
  v_and_b32 v91, s98, v197
  v_lshlrev_b32 v92, 16, v198
  v_and_b32 v93, s98, v198
  v_lshlrev_b32 v94, 16, v199
  v_and_b32 v95, s98, v199
  v_pk_fma_f32 v[88:89], v[88:89], v[68:69], v[64:65]
  v_pk_fma_f32 v[90:91], v[90:91], v[68:69], v[64:65]
  v_pk_fma_f32 v[92:93], v[92:93], v[68:69], v[64:65]
  v_pk_fma_f32 v[94:95], v[94:95], v[68:69], v[64:65]
  v_cvt_pk_bf16_f32 v108, v88, v89
  v_cvt_pk_bf16_f32 v109, v90, v91
  v_cvt_pk_bf16_f32 v110, v92, v93
  v_cvt_pk_bf16_f32 v111, v94, v95
  ds_write_b128 v79, v[108:111] offset:8192
  s_add_u32 m0, s79, 57344
  s_nop 0
  buffer_load_dwordx4 v10, s[28:31], s63 offen lds
  v_lshlrev_b32 v80, 16, v200
  v_and_b32 v81, s98, v200
  v_lshlrev_b32 v82, 16, v201
  v_and_b32 v83, s98, v201
  v_lshlrev_b32 v84, 16, v202
  v_and_b32 v85, s98, v202
  v_lshlrev_b32 v86, 16, v203
  v_and_b32 v87, s98, v203
  v_pk_fma_f32 v[80:81], v[80:81], v[68:69], v[64:65]
  v_pk_fma_f32 v[82:83], v[82:83], v[68:69], v[64:65]
  v_pk_fma_f32 v[84:85], v[84:85], v[68:69], v[64:65]
  v_pk_fma_f32 v[86:87], v[86:87], v[68:69], v[64:65]
  v_cvt_pk_bf16_f32 v96, v80, v81
  v_cvt_pk_bf16_f32 v97, v82, v83
  v_cvt_pk_bf16_f32 v98, v84, v85
  v_cvt_pk_bf16_f32 v99, v86, v87
  ds_write_b128 v78, v[96:99] offset:16384
  buffer_load_dwordx4 v11, s[28:31], s63 offen offset:1024 lds
  v_lshlrev_b32 v88, 16, v204
  v_and_b32 v89, s98, v204
  v_lshlrev_b32 v90, 16, v205
  v_and_b32 v91, s98, v205
  v_lshlrev_b32 v92, 16, v206
  v_and_b32 v93, s98, v206
  v_lshlrev_b32 v94, 16, v207
  v_and_b32 v95, s98, v207
  v_pk_fma_f32 v[88:89], v[88:89], v[68:69], v[64:65]
  v_pk_fma_f32 v[90:91], v[90:91], v[68:69], v[64:65]
  v_pk_fma_f32 v[92:93], v[92:93], v[68:69], v[64:65]
  v_pk_fma_f32 v[94:95], v[94:95], v[68:69], v[64:65]
  v_cvt_pk_bf16_f32 v100, v88, v89
  v_cvt_pk_bf16_f32 v101, v90, v91
  v_cvt_pk_bf16_f32 v102, v92, v93
  v_cvt_pk_bf16_f32 v103, v94, v95
  ds_write_b128 v79, v[100:103] offset:16384
  s_add_u32 m0, s79, 65536
  s_nop 0
  buffer_load_dwordx4 v10, s[28:31], s64 offen lds
  v_lshlrev_b32 v80, 16, v208
  v_and_b32 v81, s98, v208
  v_lshlrev_b32 v82, 16, v209
  v_and_b32 v83, s98, v209
  v_lshlrev_b32 v84, 16, v210
  v_and_b32 v85, s98, v210
  v_lshlrev_b32 v86, 16, v211
  v_and_b32 v87, s98, v211
  v_pk_fma_f32 v[80:81], v[80:81], v[68:69], v[64:65]
  v_pk_fma_f32 v[82:83], v[82:83], v[68:69], v[64:65]
  v_pk_fma_f32 v[84:85], v[84:85], v[68:69], v[64:65]
  v_pk_fma_f32 v[86:87], v[86:87], v[68:69], v[64:65]
  v_cvt_pk_bf16_f32 v104, v80, v81
  v_cvt_pk_bf16_f32 v105, v82, v83
  v_cvt_pk_bf16_f32 v106, v84, v85
  v_cvt_pk_bf16_f32 v107, v86, v87
  ds_write_b128 v78, v[104:107] offset:24576
  buffer_load_dwordx4 v11, s[28:31], s64 offen offset:1024 lds
  buffer_load_dword v249, v246, s[28:31], 0 offen
  v_lshlrev_b32 v88, 16, v212
  v_and_b32 v89, s98, v212
  v_lshlrev_b32 v90, 16, v213
  v_and_b32 v91, s98, v213
  v_lshlrev_b32 v92, 16, v214
  v_and_b32 v93, s98, v214
  v_lshlrev_b32 v94, 16, v215
  v_and_b32 v95, s98, v215
  v_pk_fma_f32 v[88:89], v[88:89], v[68:69], v[64:65]
  v_pk_fma_f32 v[90:91], v[90:91], v[68:69], v[64:65]
  v_pk_fma_f32 v[92:93], v[92:93], v[68:69], v[64:65]
  v_pk_fma_f32 v[94:95], v[94:95], v[68:69], v[64:65]
  v_cvt_pk_bf16_f32 v108, v88, v89
  v_cvt_pk_bf16_f32 v109, v90, v91
  v_cvt_pk_bf16_f32 v110, v92, v93
  v_cvt_pk_bf16_f32 v111, v94, v95
  ds_write_b128 v79, v[108:111] offset:24576
  buffer_load_dword v249, v247, s[32:35], 0 offen
  v_lshlrev_b32 v80, 16, v216
  v_and_b32 v81, s98, v216
  v_lshlrev_b32 v82, 16, v217
  v_and_b32 v83, s98, v217
  v_lshlrev_b32 v84, 16, v218
  v_and_b32 v85, s98, v218
  v_lshlrev_b32 v86, 16, v219
  v_and_b32 v87, s98, v219
  v_pk_fma_f32 v[80:81], v[80:81], v[68:69], v[64:65]
  v_pk_fma_f32 v[82:83], v[82:83], v[68:69], v[64:65]
  v_pk_fma_f32 v[84:85], v[84:85], v[68:69], v[64:65]
  v_pk_fma_f32 v[86:87], v[86:87], v[68:69], v[64:65]
  v_cvt_pk_bf16_f32 v96, v80, v81
  v_cvt_pk_bf16_f32 v97, v82, v83
  v_cvt_pk_bf16_f32 v98, v84, v85
  v_cvt_pk_bf16_f32 v99, v86, v87
  ds_write_b128 v78, v[96:99] offset:32768
  buffer_load_dwordx4 v[32:35], v242, s[48:51], 0 offen
  v_lshlrev_b32 v88, 16, v220
  v_and_b32 v89, s98, v220
  v_lshlrev_b32 v90, 16, v221
  v_and_b32 v91, s98, v221
  v_lshlrev_b32 v92, 16, v222
  v_and_b32 v93, s98, v222
  v_lshlrev_b32 v94, 16, v223
  v_and_b32 v95, s98, v223
  v_pk_fma_f32 v[88:89], v[88:89], v[68:69], v[64:65]
  v_pk_fma_f32 v[90:91], v[90:91], v[68:69], v[64:65]
  v_pk_fma_f32 v[92:93], v[92:93], v[68:69], v[64:65]
  v_pk_fma_f32 v[94:95], v[94:95], v[68:69], v[64:65]
  v_cvt_pk_bf16_f32 v100, v88, v89
  v_cvt_pk_bf16_f32 v101, v90, v91
  v_cvt_pk_bf16_f32 v102, v92, v93
  v_cvt_pk_bf16_f32 v103, v94, v95
  ds_write_b128 v79, v[100:103] offset:32768
  buffer_load_dwordx4 v[36:39], v242, s[48:51], 0 offen offset:16
  s_cmp_lg_u32 s78, 0
  s_cbranch_scc1 K1_NOSTAT
  v_and_b32 v2, 3, v1
  v_cmp_eq_u32 vcc, 0, v2
  v_lshrrev_b32 v2, 2, v1
  s_lshl_b32 s82, s77, 6
  s_lshl_b32 s83, s74, 4
  s_add_u32 s82, s82, s83
  v_add_u32 v2, s82, v2
  v_lshlrev_b32 v2, 3, v2
  v_add_u32 v2, 29360128, v2
  s_and_saveexec_b64 s[86:87], vcc
  buffer_store_dwordx2 v[66:67], v2, s[36:39], 0 offen sc1
  s_mov_b64 exec, s[86:87]
K1_NOSTAT:
  v_and_b32 v2, 31, v1
  s_lshl_b32 s82, s75, 5
  v_add_u32 v2, s82, v2
  v_bfe_u32 v3, v2, 1, 3
  v_lshrrev_b32 v4, 5, v1
  v_xor_b32 v3, v3, v4
  v_lshlrev_b32 v3, 4, v3
  v_lshl_add_u32 v3, v2, 7, v3
  v_add_u32 v2, 73728, v3
  v_xor_b32 v3, 32, v2
  v_xor_b32 v4, 64, v2
  v_xor_b32 v5, 96, v2
  v_add_u32 v6, 32768, v2
  v_add_u32 v7, 32768, v3
  v_add_u32 v8, 32768, v4
  v_add_u32 v9, 32768, v5
  s_waitcnt lgkmcnt(0)
  s_barrier
  ds_read_b128 a[0:3], v2 offset:0
  ds_read_b128 a[4:7], v3 offset:0
  ds_read_b128 a[8:11], v4 offset:0
  ds_read_b128 a[12:15], v5 offset:0
  ds_read_b128 a[16:19], v2 offset:8192
  ds_read_b128 a[20:23], v3 offset:8192
  ds_read_b128 a[24:27], v4 offset:8192
  ds_read_b128 a[28:31], v5 offset:8192
  ds_read_b128 a[32:35], v2 offset:16384
  ds_read_b128 a[36:39], v3 offset:16384
  ds_read_b128 a[40:43], v4 offset:16384
  ds_read_b128 a[44:47], v5 offset:16384
  ds_read_b128 a[48:51], v2 offset:24576
  ds_read_b128 a[52:55], v3 offset:24576
  ds_read_b128 a[56:59], v4 offset:24576
  ds_read_b128 a[60:63], v5 offset:24576
  ds_read_b128 a[64:67], v6 offset:0
  ds_read_b128 a[68:71], v7 offset:0
  ds_read_b128 a[72:75], v8 offset:0
  ds_read_b128 a[76:79], v9 offset:0
  ds_read_b128 a[80:83], v6 offset:8192
  ds_read_b128 a[84:87], v7 offset:8192
  ds_read_b128 a[88:91], v8 offset:8192
  ds_read_b128 a[92:95], v9 offset:8192
  ds_read_b128 a[96:99], v6 offset:16384
  ds_read_b128 a[100:103], v7 offset:16384
  ds_read_b128 a[104:107], v8 offset:16384
  ds_read_b128 a[108:111], v9 offset:16384
  ds_read_b128 a[112:115], v6 offset:24576
  ds_read_b128 a[116:119], v7 offset:24576
  ds_read_b128 a[120:123], v8 offset:24576
  ds_read_b128 a[124:127], v9 offset:24576
  ds_read_b128 a[128:131], v6 offset:32768
  ds_read_b128 a[132:135], v7 offset:32768
  ds_read_b128 a[136:139], v8 offset:32768
  ds_read_b128 a[140:143], v9 offset:32768
  v_and_b32 v14, 15, v1
  v_lshrrev_b32 v15, 5, v1
  v_bfe_u32 v64, v1, 4, 1
  v_lshlrev_b32 v64, 5, v64
  v_and_b32 v65, 3, v14
  v_lshl_add_u32 v64, v65, 3, v64
  s_lshl_b32 s82, s76, 6
  v_add_u32 v64, s82, v64
  v_bfe_u32 v65, v14, 3, 1
  v_lshlrev_b32 v65, 6, v65
  v_xor_b32 v64, v64, v65
  v_lshrrev_b32 v65, 2, v14
  v_lshl_add_u32 v66, v15, 3, v65
  v_lshl_add_u32 v2, v66, 7, v64
  v_add_u32 v3, 65536, v2
  v_lshl_add_u32 v66, v15, 2, v65
  v_lshl_add_u32 v66, v66, 7, v64
  s_lshl_b32 s82, s76, 12
  s_add_u32 s83, s82, 73728
  v_add_u32 v4, s83, v66
  v_add_u32 v5, 65536, v4
  s_xor_b32 s82, s82, 4096
  s_add_u32 s83, s82, 73728
  v_add_u32 v6, s83, v66
  v_add_u32 v7, 65536, v6
  v_lshlrev_b32 v64, 4, v1
  s_add_u32 s82, s79, 147456
  v_add_u32 v8, s82, v64
  v_xor_b32 v9, 2048, v8
  s_waitcnt vmcnt(4) lgkmcnt(0)
  s_barrier
  v_add_u32 v10, 128, v10
  v_add_u32 v11, 128, v11
  ds_read_b64_tr_b16 a[144:145], v2 offset:0
  ds_read_b64_tr_b16 a[146:147], v2 offset:512
  ds_read_b64_tr_b16 a[148:149], v2 offset:2048
  ds_read_b64_tr_b16 a[150:151], v2 offset:2560
  ds_read_b64_tr_b16 a[152:153], v2 offset:4096
  ds_read_b64_tr_b16 a[154:155], v2 offset:4608
  ds_read_b64_tr_b16 a[156:157], v2 offset:6144
  ds_read_b64_tr_b16 a[158:159], v2 offset:6656
  ds_read_b64_tr_b16 a[160:161], v2 offset:8192
  ds_read_b64_tr_b16 a[162:163], v2 offset:8704
  ds_read_b64_tr_b16 a[164:165], v2 offset:10240
  ds_read_b64_tr_b16 a[166:167], v2 offset:10752
  ds_read_b64_tr_b16 a[168:169], v2 offset:12288
  ds_read_b64_tr_b16 a[170:171], v2 offset:12800
  s_waitcnt lgkmcnt(6)
  v_mfma_f32_32x32x16_bf16 v[16:31], a[144:147], a[0:3], 0
  ds_read_b64_tr_b16 a[172:173], v2 offset:14336
  ds_read_b64_tr_b16 a[174:175], v2 offset:14848
  s_add_u32 m0, s95, 0
  s_nop 0
  buffer_load_dwordx4 v228, s[40:43], 0 offen lds
  v_mfma_f32_32x32x16_bf16 v[16:31], a[148:151], a[4:7], v[16:31]
  ds_read_b64_tr_b16 a[144:145], v2 offset:16384
  ds_read_b64_tr_b16 a[146:147], v2 offset:16896
  s_add_u32 m0, s95, 12288
  s_nop 0
  buffer_load_dwordx4 v231, s[44:47], s94 offen lds
  v_mfma_f32_32x32x16_bf16 v[16:31], a[152:155], a[8:11], v[16:31]
  ds_read_b64_tr_b16 a[148:149], v2 offset:18432
  ds_read_b64_tr_b16 a[150:151], v2 offset:18944
  v_mfma_f32_32x32x16_bf16 v[16:31], a[156:159], a[12:15], v[16:31]
  ds_read_b64_tr_b16 a[152:153], v2 offset:20480
  ds_read_b64_tr_b16 a[154:155], v2 offset:20992
  s_add_u32 m0, s95, 4096
  s_nop 0
  buffer_load_dwordx4 v229, s[40:43], 0 offen lds
  s_waitcnt lgkmcnt(6)
  v_mfma_f32_32x32x16_bf16 v[16:31], a[160:163], a[16:19], v[16:31]
  ds_read_b64_tr_b16 a[156:157], v2 offset:22528
  ds_read_b64_tr_b16 a[158:159], v2 offset:23040
  v_mfma_f32_32x32x16_bf16 v[16:31], a[164:167], a[20:23], v[16:31]
  ds_read_b64_tr_b16 a[160:161], v2 offset:24576
  ds_read_b64_tr_b16 a[162:163], v2 offset:25088
  s_add_u32 m0, s95, 16384
  s_nop 0
  buffer_load_dwordx4 v232, s[44:47], s94 offen lds
  v_mfma_f32_32x32x16_bf16 v[16:31], a[168:171], a[24:27], v[16:31]
  ds_read_b64_tr_b16 a[164:165], v2 offset:26624
  ds_read_b64_tr_b16 a[166:167], v2 offset:27136
  v_mfma_f32_32x32x16_bf16 v[16:31], a[172:175], a[28:31], v[16:31]
  ds_read_b64_tr_b16 a[168:169], v2 offset:28672
  ds_read_b64_tr_b16 a[170:171], v2 offset:29184
  s_add_u32 m0, s95, 8192
  s_nop 0
  buffer_load_dwordx4 v230, s[40:43], 0 offen lds
  s_waitcnt lgkmcnt(6)
  v_mfma_f32_32x32x16_bf16 v[16:31], a[144:147], a[32:35], v[16:31]
  ds_read_b64_tr_b16 a[172:173], v2 offset:30720
  ds_read_b64_tr_b16 a[174:175], v2 offset:31232
  v_mfma_f32_32x32x16_bf16 v[16:31], a[148:151], a[36:39], v[16:31]
  ds_read_b64_tr_b16 a[144:145], v2 offset:32768
  ds_read_b64_tr_b16 a[146:147], v2 offset:33280
  s_add_u32 m0, s95, 20480
  s_nop 0
  buffer_load_dwordx4 v233, s[44:47], s94 offen lds
  v_mfma_f32_32x32x16_bf16 v[16:31], a[152:155], a[40:43], v[16:31]
  ds_read_b64_tr_b16 a[148:149], v2 offset:34816
  ds_read_b64_tr_b16 a[150:151], v2 offset:35328
  v_mfma_f32_32x32x16_bf16 v[16:31], a[156:159], a[44:47], v[16:31]
  ds_read_b64_tr_b16 a[152:153], v2 offset:36864
  ds_read_b64_tr_b16 a[154:155], v2 offset:37376
  s_barrier
  s_waitcnt lgkmcnt(6)
  v_mfma_f32_32x32x16_bf16 v[16:31], a[160:163], a[48:51], v[16:31]
  ds_read_b64_tr_b16 a[156:157], v2 offset:38912
  ds_read_b64_tr_b16 a[158:159], v2 offset:39424
  s_add_u32 m0, s79, 0
  s_mul_i32 s82, s2, 3641
  s_lshr_b32 s82, s82, 16
  s_min_u32 s82, s82, 7
  s_lshl_b32 s82, s82, 12
  s_add_u32 s82, s82, 31457280
  v_mfma_f32_32x32x16_bf16 v[16:31], a[164:167], a[52:55], v[16:31]
  ds_read_b64_tr_b16 a[160:161], v2 offset:40960
  ds_read_b64_tr_b16 a[162:163], v2 offset:41472
  buffer_load_dwordx4 v10, s[28:31], s56 offen lds
  v_mfma_f32_32x32x16_bf16 v[16:31], a[168:171], a[56:59], v[16:31]
  ds_read_b64_tr_b16 a[164:165], v2 offset:43008
  ds_read_b64_tr_b16 a[166:167], v2 offset:43520
  v_and_b32 v254, 31, v1
  v_mfma_f32_32x32x16_bf16 v[16:31], a[172:175], a[60:63], v[16:31]
  ds_read_b64_tr_b16 a[168:169], v2 offset:45056
  ds_read_b64_tr_b16 a[170:171], v2 offset:45568
  buffer_load_dwordx4 v11, s[28:31], s56 offen offset:1024 lds
  s_waitcnt lgkmcnt(6)
  v_mfma_f32_32x32x16_bf16 v[16:31], a[144:147], a[64:67], v[16:31]
  ds_read_b64_tr_b16 a[172:173], v2 offset:47104
  ds_read_b64_tr_b16 a[174:175], v2 offset:47616
  s_add_u32 m0, s79, 8192
  v_lshlrev_b32 v254, 7, v254
  v_mfma_f32_32x32x16_bf16 v[16:31], a[148:151], a[68:71], v[16:31]
  ds_read_b64_tr_b16 a[144:145], v2 offset:49152
  ds_read_b64_tr_b16 a[146:147], v2 offset:49664
  buffer_load_dwordx4 v10, s[28:31], s57 offen lds
  v_mfma_f32_32x32x16_bf16 v[16:31], a[152:155], a[72:75], v[16:31]
  ds_read_b64_tr_b16 a[148:149], v2 offset:51200
  ds_read_b64_tr_b16 a[150:151], v2 offset:51712
  v_add_u32 v254, s82, v254
  v_mfma_f32_32x32x16_bf16 v[16:31], a[156:159], a[76:79], v[16:31]
  ds_read_b64_tr_b16 a[152:153], v2 offset:53248
  ds_read_b64_tr_b16 a[154:155], v2 offset:53760
  buffer_load_dwordx4 v11, s[28:31], s57 offen offset:1024 lds
  s_waitcnt lgkmcnt(6)
  v_mfma_f32_32x32x16_bf16 v[16:31], a[160:163], a[80:83], v[16:31]
  ds_read_b64_tr_b16 a[156:157], v2 offset:55296
  ds_read_b64_tr_b16 a[158:159], v2 offset:55808
  s_add_u32 m0, s79, 16384
  s_lshl_b32 s82, s2, 2
  s_add_u32 s82, s82, s74
  s_lshl_b32 s82, s82, 12
  v_mfma_f32_32x32x16_bf16 v[16:31], a[164:167], a[84:87], v[16:31]
  ds_read_b64_tr_b16 a[160:161], v2 offset:57344
  ds_read_b64_tr_b16 a[162:163], v2 offset:57856
  buffer_load_dwordx4 v10, s[28:31], s58 offen lds
  v_mfma_f32_32x32x16_bf16 v[16:31], a[168:171], a[88:91], v[16:31]
  ds_read_b64_tr_b16 a[164:165], v2 offset:59392
  ds_read_b64_tr_b16 a[166:167], v2 offset:59904
  v_lshlrev_b32 v240, 7, v1
  v_mfma_f32_32x32x16_bf16 v[16:31], a[172:175], a[92:95], v[16:31]
  ds_read_b64_tr_b16 a[168:169], v2 offset:61440
  ds_read_b64_tr_b16 a[170:171], v2 offset:61952
  buffer_load_dwordx4 v11, s[28:31], s58 offen offset:1024 lds
  s_barrier
  s_waitcnt lgkmcnt(6)
  v_mfma_f32_32x32x16_bf16 v[16:31], a[144:147], a[96:99], v[16:31]
  ds_read_b64_tr_b16 a[172:173], v2 offset:63488
  ds_read_b64_tr_b16 a[174:175], v2 offset:64000
  s_add_u32 m0, s79, 24576
  v_add_u32 v240, s82, v240
  v_mfma_f32_32x32x16_bf16 v[16:31], a[148:151], a[100:103], v[16:31]
  ds_read_b64_tr_b16 a[144:145], v3 offset:0
  ds_read_b64_tr_b16 a[146:147], v3 offset:512
  buffer_load_dwordx4 v10, s[28:31], s59 offen lds
  v_mfma_f32_32x32x16_bf16 v[16:31], a[152:155], a[104:107], v[16:31]
  ds_read_b64_tr_b16 a[148:149], v3 offset:2048
  ds_read_b64_tr_b16 a[150:151], v3 offset:2560
  v_cmp_gt_u32 vcc, 6, v1
  v_mfma_f32_32x32x16_bf16 v[16:31], a[156:159], a[108:111], v[16:31]
  ds_read_b64_tr_b16 a[152:153], v3 offset:4096
  ds_read_b64_tr_b16 a[154:155], v3 offset:4608
  buffer_load_dwordx4 v11, s[28:31], s59 offen offset:1024 lds
  s_waitcnt lgkmcnt(6)
  v_mfma_f32_32x32x16_bf16 v[16:31], a[160:163], a[112:115], v[16:31]
  ds_read_b64_tr_b16 a[156:157], v3 offset:6144
  ds_read_b64_tr_b16 a[158:159], v3 offset:6656
  s_add_u32 m0, s79, 32768
  v_mov_b32 v14, 0x80000000
  v_mfma_f32_32x32x16_bf16 v[16:31], a[164:167], a[116:119], v[16:31]
  buffer_load_dwordx4 v10, s[28:31], s60 offen lds
  v_mfma_f32_32x32x16_bf16 v[16:31], a[168:171], a[120:123], v[16:31]
  s_nop 0
  v_mfma_f32_32x32x16_bf16 v[16:31], a[172:175], a[124:127], v[16:31]
  buffer_load_dwordx4 v11, s[28:31], s60 offen offset:1024 lds
  s_waitcnt lgkmcnt(0)
  v_mfma_f32_32x32x16_bf16 v[16:31], a[144:147], a[128:131], v[16:31]
  s_add_u32 m0, s79, 40960
  v_cndmask_b32 v240, v14, v240, vcc
  v_mfma_f32_32x32x16_bf16 v[16:31], a[148:151], a[132:135], v[16:31]
  buffer_load_dwordx4 v10, s[28:31], s61 offen lds
  v_mfma_f32_32x32x16_bf16 v[16:31], a[152:155], a[136:139], v[16:31]
  v_mfma_f32_32x32x16_bf16 v[16:31], a[156:159], a[140:143], v[16:31]
  buffer_load_dwordx4 v11, s[28:31], s61 offen offset:1024 lds
  s_waitcnt vmcnt(12)
  s_barrier
  v_mov_b32 v252, 0
  global_load_dword v253, v252, s[20:21] sc1
  ds_read_b64 v[80:81], v241 offset:0
  s_add_u32 m0, s79, 49152
  s_nop 0
  buffer_load_dwordx4 v10, s[28:31], s62 offen lds
  buffer_load_dwordx4 v11, s[28:31], s62 offen offset:1024 lds
  ds_read_b64 v[82:83], v241 offset:144
  ds_read_b64 v[84:85], v241 offset:288
  ds_read_b64 v[86:87], v241 offset:432
  ds_read_b64 v[88:89], v241 offset:576
  ds_read_b64 v[90:91], v241 offset:720
  ds_read_b64 v[92:93], v241 offset:864
  ds_read_b64 v[94:95], v241 offset:1008
  ds_read_b64 v[96:97], v241 offset:1152
  ds_read_b64 v[98:99], v241 offset:1296
  ds_read_b64 v[100:101], v241 offset:1440
  ds_read_b64 v[102:103], v241 offset:12288
  ds_read_b64 v[104:105], v241 offset:12432
  ds_read_b64 v[106:107], v241 offset:12576
  ds_read_b64 v[108:109], v241 offset:12720
  ds_read_b64 v[110:111], v241 offset:12864
  ds_read_b64 v[112:113], v241 offset:13008
  ds_read_b64 v[114:115], v241 offset:13152
  ds_read_b64 v[116:117], v241 offset:13296
  v_exp_f32 v64, v16
  v_exp_f32 v65, v17
  v_add_f32 v64, 1.0, v64
  v_add_f32 v65, 1.0, v65
  v_rcp_f32 v64, v64
  v_rcp_f32 v65, v65
  v_mul_f32 v64, v64, v16
  v_mul_f32 v65, v65, v17
  s_add_u32 m0, s79, 57344
  s_nop 0
  buffer_load_dwordx4 v10, s[28:31], s63 offen lds
  buffer_load_dwordx4 v11, s[28:31], s63 offen offset:1024 lds
  v_cvt_pk_bf16_f32 v48, v64, v65
  v_exp_f32 v66, v18
  v_exp_f32 v67, v19
  v_add_f32 v66, 1.0, v66
  v_add_f32 v67, 1.0, v67
  v_rcp_f32 v66, v66
  v_rcp_f32 v67, v67
  v_mul_f32 v66, v66, v18
  v_mul_f32 v67, v67, v19
  v_cvt_pk_bf16_f32 v49, v66, v67
  v_exp_f32 v68, v20
  v_exp_f32 v69, v21
  v_add_f32 v68, 1.0, v68
  v_add_f32 v69, 1.0, v69
  v_rcp_f32 v68, v68
  v_rcp_f32 v69, v69
  v_mul_f32 v68, v68, v20
  v_mul_f32 v69, v69, v21
  v_cvt_pk_bf16_f32 v50, v68, v69
  v_exp_f32 v70, v22
  v_exp_f32 v71, v23
  v_add_f32 v70, 1.0, v70
  v_add_f32 v71, 1.0, v71
  v_rcp_f32 v70, v70
  v_rcp_f32 v71, v71
  s_add_u32 m0, s79, 65536
  s_nop 0
  buffer_load_dwordx4 v10, s[28:31], s64 offen lds
  buffer_load_dwordx4 v11, s[28:31], s64 offen offset:1024 lds
  v_mul_f32 v70, v70, v22
  v_mul_f32 v71, v71, v23
  v_cvt_pk_bf16_f32 v51, v70, v71
  v_exp_f32 v64, v24
  v_exp_f32 v65, v25
  v_add_f32 v64, 1.0, v64
  v_add_f32 v65, 1.0, v65
  v_rcp_f32 v64, v64
  v_rcp_f32 v65, v65
  v_mul_f32 v64, v64, v24
  v_mul_f32 v65, v65, v25
  v_cvt_pk_bf16_f32 v52, v64, v65
  v_exp_f32 v66, v26
  v_exp_f32 v67, v27
  v_add_f32 v66, 1.0, v66
  v_add_f32 v67, 1.0, v67
  v_rcp_f32 v66, v66
  v_rcp_f32 v67, v67
  v_mul_f32 v66, v66, v26
  v_mul_f32 v67, v67, v27
  v_cvt_pk_bf16_f32 v53, v66, v67
  v_exp_f32 v68, v28
  v_exp_f32 v69, v29
  v_add_f32 v68, 1.0, v68
  v_add_f32 v69, 1.0, v69
  v_rcp_f32 v68, v68
  v_add_u32 v10, 128, v10
  v_add_u32 v11, 128, v11
  v_rcp_f32 v69, v69
  v_mul_f32 v68, v68, v28
  v_mul_f32 v69, v69, v29
  v_cvt_pk_bf16_f32 v54, v68, v69
  v_exp_f32 v70, v30
  v_exp_f32 v71, v31
  v_add_f32 v70, 1.0, v70
  v_add_f32 v71, 1.0, v71
  v_rcp_f32 v70, v70
  v_rcp_f32 v71, v71
  v_mul_f32 v70, v70, v30
  v_mul_f32 v71, v71, v31
  v_cvt_pk_bf16_f32 v55, v70, v71
  v_lshlrev_b32 v172, 16, v32
  v_and_b32 v176, s98, v32
  v_lshlrev_b32 v180, 16, v33
  v_and_b32 v184, s98, v33
  v_lshlrev_b32 v173, 16, v34
  v_and_b32 v177, s98, v34
  v_lshlrev_b32 v181, 16, v35
  v_and_b32 v185, s98, v35
  v_lshlrev_b32 v174, 16, v36
  v_and_b32 v178, s98, v36
  v_lshlrev_b32 v182, 16, v37
  v_and_b32 v186, s98, v37
  s_add_u32 m0, s80, 0
  s_nop 0
  buffer_load_dwordx4 v12, s[32:35], s65 offen lds
  buffer_load_dwordx4 v13, s[32:35], s65 offen offset:1024 lds
  v_lshlrev_b32 v175, 16, v38
  v_and_b32 v179, s98, v38
  v_lshlrev_b32 v183, 16, v39
  v_and_b32 v187, s98, v39
  s_waitcnt lgkmcnt(8)
  v_lshlrev_b32 v128, 16, v80
  v_and_b32 v129, s98, v80
  v_lshlrev_b32 v130, 16, v81
  v_and_b32 v131, s98, v81
  v_lshlrev_b32 v132, 16, v82
  v_and_b32 v133, s98, v82
  v_lshlrev_b32 v134, 16, v83
  v_and_b32 v135, s98, v83
  v_lshlrev_b32 v136, 16, v84
  v_and_b32 v137, s98, v84
  v_lshlrev_b32 v138, 16, v85
  v_and_b32 v139, s98, v85
  v_lshlrev_b32 v140, 16, v86
  v_and_b32 v141, s98, v86
  v_lshlrev_b32 v142, 16, v87
  v_and_b32 v143, s98, v87
  v_lshlrev_b32 v144, 16, v88
  v_and_b32 v145, s98, v88
  v_lshlrev_b32 v146, 16, v89
  v_and_b32 v147, s98, v89
  v_lshlrev_b32 v148, 16, v90
  s_add_u32 m0, s80, 8192
  s_nop 0
  buffer_load_dwordx4 v12, s[32:35], s66 offen lds
  buffer_load_dwordx4 v13, s[32:35], s66 offen offset:1024 lds
  v_and_b32 v149, s98, v90
  v_lshlrev_b32 v150, 16, v91
  v_and_b32 v151, s98, v91
  v_lshlrev_b32 v152, 16, v92
  v_and_b32 v153, s98, v92
  v_lshlrev_b32 v154, 16, v93
  v_and_b32 v155, s98, v93
  v_lshlrev_b32 v156, 16, v94
  v_and_b32 v157, s98, v94
  v_lshlrev_b32 v158, 16, v95
  v_and_b32 v159, s98, v95
  v_lshlrev_b32 v160, 16, v96
  v_and_b32 v161, s98, v96
  v_lshlrev_b32 v162, 16, v97
  v_and_b32 v163, s98, v97
  v_lshlrev_b32 v164, 16, v98
  v_and_b32 v165, s98, v98
  v_lshlrev_b32 v166, 16, v99
  v_and_b32 v167, s98, v99
  v_lshlrev_b32 v168, 16, v100
  v_and_b32 v169, s98, v100
  v_lshlrev_b32 v170, 16, v101
  v_and_b32 v171, s98, v101
  s_waitcnt lgkmcnt(0)
  v_pk_mul_f32 v[188:189], v[140:141], v[172:173]
  s_add_u32 m0, s80, 16384
  s_nop 0
  buffer_load_dwordx4 v12, s[32:35], s67 offen lds
  buffer_load_dwordx4 v13, s[32:35], s67 offen offset:1024 lds
  v_pk_mul_f32 v[190:191], v[142:143], v[174:175]
  v_pk_fma_f32 v[188:189], v[136:137], v[176:177], v[188:189]
  v_pk_fma_f32 v[190:191], v[138:139], v[178:179], v[190:191]
  v_pk_fma_f32 v[188:189], v[132:133], v[180:181], v[188:189]
  v_pk_fma_f32 v[190:191], v[134:135], v[182:183], v[190:191]
  v_pk_fma_f32 v[188:189], v[128:129], v[184:185], v[188:189]
  v_pk_fma_f32 v[190:191], v[130:131], v[186:187], v[190:191]
  v_lshlrev_b32 v80, 16, v102
  v_and_b32 v81, s98, v102
  v_lshlrev_b32 v82, 16, v103
  v_and_b32 v83, s98, v103
  v_pk_mul_f32 v[188:189], v[188:189], v[80:81]
  v_pk_mul_f32 v[190:191], v[190:191], v[82:83]
  v_pk_mul_f32 v[192:193], v[144:145], v[172:173]
  v_pk_mul_f32 v[194:195], v[146:147], v[174:175]
  v_pk_fma_f32 v[192:193], v[140:141], v[176:177], v[192:193]
  v_pk_fma_f32 v[194:195], v[142:143], v[178:179], v[194:195]
  v_pk_fma_f32 v[192:193], v[136:137], v[180:181], v[192:193]
  v_pk_fma_f32 v[194:195], v[138:139], v[182:183], v[194:195]
  v_pk_fma_f32 v[192:193], v[132:133], v[184:185], v[192:193]
  v_pk_fma_f32 v[194:195], v[134:135], v[186:187], v[194:195]
  v_lshlrev_b32 v80, 16, v104
  v_and_b32 v81, s98, v104
  v_lshlrev_b32 v82, 16, v105
  v_and_b32 v83, s98, v105
  v_pk_mul_f32 v[192:193], v[192:193], v[80:81]
  s_add_u32 m0, s80, 24576
  s_nop 0
  buffer_load_dwordx4 v12, s[32:35], s68 offen lds
  buffer_load_dwordx4 v13, s[32:35], s68 offen offset:1024 lds
  v_pk_mul_f32 v[194:195], v[194:195], v[82:83]
  v_pk_mul_f32 v[196:197], v[148:149], v[172:173]
  v_pk_mul_f32 v[198:199], v[150:151], v[174:175]
  v_pk_fma_f32 v[196:197], v[144:145], v[176:177], v[196:197]
  v_pk_fma_f32 v[198:199], v[146:147], v[178:179], v[198:199]
  v_pk_fma_f32 v[196:197], v[140:141], v[180:181], v[196:197]
  v_pk_fma_f32 v[198:199], v[142:143], v[182:183], v[198:199]
  v_pk_fma_f32 v[196:197], v[136:137], v[184:185], v[196:197]
  v_pk_fma_f32 v[198:199], v[138:139], v[186:187], v[198:199]
  v_lshlrev_b32 v80, 16, v106
  v_and_b32 v81, s98, v106
  v_lshlrev_b32 v82, 16, v107
  v_and_b32 v83, s98, v107
  v_pk_mul_f32 v[196:197], v[196:197], v[80:81]
  v_pk_mul_f32 v[198:199], v[198:199], v[82:83]
  v_pk_mul_f32 v[200:201], v[152:153], v[172:173]
  v_pk_mul_f32 v[202:203], v[154:155], v[174:175]
  v_pk_fma_f32 v[200:201], v[148:149], v[176:177], v[200:201]
  v_pk_fma_f32 v[202:203], v[150:151], v[178:179], v[202:203]
  v_pk_fma_f32 v[200:201], v[144:145], v[180:181], v[200:201]
  v_pk_fma_f32 v[202:203], v[146:147], v[182:183], v[202:203]
  v_pk_fma_f32 v[200:201], v[140:141], v[184:185], v[200:201]
  v_pk_fma_f32 v[202:203], v[142:143], v[186:187], v[202:203]
  v_lshlrev_b32 v80, 16, v108
  v_and_b32 v81, s98, v108
  s_add_u32 m0, s80, 32768
  s_nop 0
  buffer_load_dwordx4 v12, s[32:35], s69 offen lds
  buffer_load_dwordx4 v13, s[32:35], s69 offen offset:1024 lds
  v_lshlrev_b32 v82, 16, v109
  v_and_b32 v83, s98, v109
  v_pk_mul_f32 v[200:201], v[200:201], v[80:81]
  v_pk_mul_f32 v[202:203], v[202:203], v[82:83]
  v_pk_mul_f32 v[204:205], v[156:157], v[172:173]
  v_pk_mul_f32 v[206:207], v[158:159], v[174:175]
  v_pk_fma_f32 v[204:205], v[152:153], v[176:177], v[204:205]
  v_pk_fma_f32 v[206:207], v[154:155], v[178:179], v[206:207]
  v_pk_fma_f32 v[204:205], v[148:149], v[180:181], v[204:205]
  v_pk_fma_f32 v[206:207], v[150:151], v[182:183], v[206:207]
  v_pk_fma_f32 v[204:205], v[144:145], v[184:185], v[204:205]
  v_pk_fma_f32 v[206:207], v[146:147], v[186:187], v[206:207]
  v_lshlrev_b32 v80, 16, v110
  v_and_b32 v81, s98, v110
  v_lshlrev_b32 v82, 16, v111
  v_and_b32 v83, s98, v111
  v_pk_mul_f32 v[204:205], v[204:205], v[80:81]
  v_pk_mul_f32 v[206:207], v[206:207], v[82:83]
  v_pk_mul_f32 v[208:209], v[160:161], v[172:173]
  v_pk_mul_f32 v[210:211], v[162:163], v[174:175]
  v_pk_fma_f32 v[208:209], v[156:157], v[176:177], v[208:209]
  v_pk_fma_f32 v[210:211], v[158:159], v[178:179], v[210:211]
  v_pk_fma_f32 v[208:209], v[152:153], v[180:181], v[208:209]
  v_pk_fma_f32 v[210:211], v[154:155], v[182:183], v[210:211]
  v_pk_fma_f32 v[208:209], v[148:149], v[184:185], v[208:209]
  v_pk_fma_f32 v[210:211], v[150:151], v[186:187], v[210:211]
  s_add_u32 m0, s80, 40960
  s_nop 0
  buffer_load_dwordx4 v12, s[32:35], s70 offen lds
  buffer_load_dwordx4 v13, s[32:35], s70 offen offset:1024 lds
  v_lshlrev_b32 v80, 16, v112
  v_and_b32 v81, s98, v112
  v_lshlrev_b32 v82, 16, v113
  v_and_b32 v83, s98, v113
  v_pk_mul_f32 v[208:209], v[208:209], v[80:81]
  v_pk_mul_f32 v[210:211], v[210:211], v[82:83]
  v_pk_mul_f32 v[212:213], v[164:165], v[172:173]
  v_pk_mul_f32 v[214:215], v[166:167], v[174:175]
  v_pk_fma_f32 v[212:213], v[160:161], v[176:177], v[212:213]
  v_pk_fma_f32 v[214:215], v[162:163], v[178:179], v[214:215]
  v_pk_fma_f32 v[212:213], v[156:157], v[180:181], v[212:213]
  v_pk_fma_f32 v[214:215], v[158:159], v[182:183], v[214:215]
  v_pk_fma_f32 v[212:213], v[152:153], v[184:185], v[212:213]
  v_pk_fma_f32 v[214:215], v[154:155], v[186:187], v[214:215]
  v_lshlrev_b32 v80, 16, v114
  v_and_b32 v81, s98, v114
  v_lshlrev_b32 v82, 16, v115
  v_and_b32 v83, s98, v115
  v_pk_mul_f32 v[212:213], v[212:213], v[80:81]
  v_pk_mul_f32 v[214:215], v[214:215], v[82:83]
  v_pk_mul_f32 v[216:217], v[168:169], v[172:173]
  v_pk_mul_f32 v[218:219], v[170:171], v[174:175]
  v_pk_fma_f32 v[216:217], v[164:165], v[176:177], v[216:217]
  v_pk_fma_f32 v[218:219], v[166:167], v[178:179], v[218:219]
  v_pk_fma_f32 v[216:217], v[160:161], v[180:181], v[216:217]
  v_pk_fma_f32 v[218:219], v[162:163], v[182:183], v[218:219]
  v_pk_fma_f32 v[216:217], v[156:157], v[184:185], v[216:217]
  v_pk_fma_f32 v[218:219], v[158:159], v[186:187], v[218:219]
  v_lshlrev_b32 v80, 16, v116
  v_and_b32 v81, s98, v116
  v_lshlrev_b32 v82, 16, v117
  v_and_b32 v83, s98, v117
  v_pk_mul_f32 v[216:217], v[216:217], v[80:81]
  v_pk_mul_f32 v[218:219], v[218:219], v[82:83]
  v_cvt_pk_bf16_f32 v128, v216, v212
  v_cvt_pk_bf16_f32 v129, v208, v204
  v_cvt_pk_bf16_f32 v130, v200, v196
  v_cvt_pk_bf16_f32 v131, v192, v188
  s_movk_i32 s82, 0
  buffer_store_dwordx4 v[128:131], v236, s[36:39], s82 offen sc1
  v_cvt_pk_bf16_f32 v132, v217, v213
  v_cvt_pk_bf16_f32 v133, v209, v205
  v_cvt_pk_bf16_f32 v134, v201, v197
  v_cvt_pk_bf16_f32 v135, v193, v189
  s_movk_i32 s82, 4112
  buffer_store_dwordx4 v[132:135], v236, s[36:39], s82 offen sc1
  v_cvt_pk_bf16_f32 v136, v218, v214
  v_cvt_pk_bf16_f32 v137, v210, v206
  v_cvt_pk_bf16_f32 v138, v202, v198
  v_cvt_pk_bf16_f32 v139, v194, v190
  s_movk_i32 s82, 8224
  buffer_store_dwordx4 v[136:139], v236, s[36:39], s82 offen sc1
  v_cvt_pk_bf16_f32 v140, v219, v215
  v_cvt_pk_bf16_f32 v141, v211, v207
  v_cvt_pk_bf16_f32 v142, v203, v199
  v_cvt_pk_bf16_f32 v143, v195, v191
  s_movk_i32 s82, 12336
  buffer_store_dwordx4 v[140:143], v236, s[36:39], s82 offen sc1
  s_waitcnt vmcnt(23)
  s_barrier
  ds_read_b64_tr_b16 a[144:145], v2 offset:0
  ds_read_b64_tr_b16 a[146:147], v2 offset:512
  ds_read_b64_tr_b16 a[148:149], v2 offset:2048
  ds_read_b64_tr_b16 a[150:151], v2 offset:2560
  ds_read_b64_tr_b16 a[152:153], v2 offset:4096
  ds_read_b64_tr_b16 a[154:155], v2 offset:4608
  ds_read_b64_tr_b16 a[156:157], v2 offset:6144
  ds_read_b64_tr_b16 a[158:159], v2 offset:6656
  ds_read_b64_tr_b16 a[160:161], v2 offset:8192
  ds_read_b64_tr_b16 a[162:163], v2 offset:8704
  ds_read_b64_tr_b16 a[164:165], v2 offset:10240
  ds_read_b64_tr_b16 a[166:167], v2 offset:10752
  ds_read_b64_tr_b16 a[168:169], v2 offset:12288
  ds_read_b64_tr_b16 a[170:171], v2 offset:12800
  s_waitcnt lgkmcnt(6)
  v_mfma_f32_32x32x16_bf16 v[32:47], a[144:147], a[0:3], 0
  ds_read_b64_tr_b16 a[172:173], v2 offset:14336
  ds_read_b64_tr_b16 a[174:175], v2 offset:14848
  s_add_u32 m0, s80, 49152
  v_mfma_f32_32x32x16_bf16 v[32:47], a[148:151], a[4:7], v[32:47]
  ds_read_b64_tr_b16 a[144:145], v2 offset:16384
  ds_read_b64_tr_b16 a[146:147], v2 offset:16896
  buffer_load_dwordx4 v12, s[32:35], s71 offen lds
  v_mfma_f32_32x32x16_bf16 v[32:47], a[152:155], a[8:11], v[32:47]
  ds_read_b64_tr_b16 a[148:149], v2 offset:18432
  ds_read_b64_tr_b16 a[150:151], v2 offset:18944
  v_mfma_f32_32x32x16_bf16 v[32:47], a[156:159], a[12:15], v[32:47]
  ds_read_b64_tr_b16 a[152:153], v2 offset:20480
  ds_read_b64_tr_b16 a[154:155], v2 offset:20992
  buffer_load_dwordx4 v13, s[32:35], s71 offen offset:1024 lds
  s_waitcnt lgkmcnt(6)
  v_mfma_f32_32x32x16_bf16 v[32:47], a[160:163], a[16:19], v[32:47]
  ds_read_b64_tr_b16 a[156:157], v2 offset:22528
  ds_read_b64_tr_b16 a[158:159], v2 offset:23040
  s_add_u32 m0, s80, 57344
  v_mfma_f32_32x32x16_bf16 v[32:47], a[164:167], a[20:23], v[32:47]
  ds_read_b64_tr_b16 a[160:161], v2 offset:24576
  ds_read_b64_tr_b16 a[162:163], v2 offset:25088
  buffer_load_dwordx4 v12, s[32:35], s72 offen lds
  v_mfma_f32_32x32x16_bf16 v[32:47], a[168:171], a[24:27], v[32:47]
  ds_read_b64_tr_b16 a[164:165], v2 offset:26624
  ds_read_b64_tr_b16 a[166:167], v2 offset:27136
  v_mfma_f32_32x32x16_bf16 v[32:47], a[172:175], a[28:31], v[32:47]
  ds_read_b64_tr_b16 a[168:169], v2 offset:28672
  ds_read_b64_tr_b16 a[170:171], v2 offset:29184
  buffer_load_dwordx4 v13, s[32:35], s72 offen offset:1024 lds
  s_waitcnt lgkmcnt(6)
  v_mfma_f32_32x32x16_bf16 v[32:47], a[144:147], a[32:35], v[32:47]
  ds_read_b64_tr_b16 a[172:173], v2 offset:30720
  ds_read_b64_tr_b16 a[174:175], v2 offset:31232
  s_add_u32 m0, s80, 65536
  v_mfma_f32_32x32x16_bf16 v[32:47], a[148:151], a[36:39], v[32:47]
  ds_read_b64_tr_b16 a[144:145], v2 offset:32768
  ds_read_b64_tr_b16 a[146:147], v2 offset:33280
  buffer_load_dwordx4 v12, s[32:35], s73 offen lds
  v_mfma_f32_32x32x16_bf16 v[32:47], a[152:155], a[40:43], v[32:47]
  ds_read_b64_tr_b16 a[148:149], v2 offset:34816
  ds_read_b64_tr_b16 a[150:151], v2 offset:35328
  v_mfma_f32_32x32x16_bf16 v[32:47], a[156:159], a[44:47], v[32:47]
  ds_read_b64_tr_b16 a[152:153], v2 offset:36864
  ds_read_b64_tr_b16 a[154:155], v2 offset:37376
  buffer_load_dwordx4 v13, s[32:35], s73 offen offset:1024 lds
  s_waitcnt vmcnt(22)
  s_barrier
  s_waitcnt lgkmcnt(6)
  v_mfma_f32_32x32x16_bf16 v[32:47], a[160:163], a[48:51], v[32:47]
  ds_read_b64_tr_b16 a[156:157], v2 offset:38912
  ds_read_b64_tr_b16 a[158:159], v2 offset:39424
  s_add_u32 m0, s79, 0
  v_mfma_f32_32x32x16_bf16 v[32:47], a[164:167], a[52:55], v[32:47]
  ds_read_b64_tr_b16 a[160:161], v2 offset:40960
  ds_read_b64_tr_b16 a[162:163], v2 offset:41472
  buffer_load_dwordx4 v10, s[28:31], s56 offen lds
  buffer_load_dword v249, v238, s[28:31], 0 offen
  v_mfma_f32_32x32x16_bf16 v[32:47], a[168:171], a[56:59], v[32:47]
  ds_read_b64_tr_b16 a[164:165], v2 offset:43008
  ds_read_b64_tr_b16 a[166:167], v2 offset:43520
  v_add_u32 v12, 73728, v12
  buffer_load_dword v249, v239, s[32:35], 0 offen
  v_mfma_f32_32x32x16_bf16 v[32:47], a[172:175], a[60:63], v[32:47]
  ds_read_b64_tr_b16 a[168:169], v2 offset:45056
  ds_read_b64_tr_b16 a[170:171], v2 offset:45568
  buffer_load_dwordx4 v11, s[28:31], s56 offen offset:1024 lds
  s_waitcnt lgkmcnt(6)
  v_mfma_f32_32x32x16_bf16 v[32:47], a[144:147], a[64:67], v[32:47]
  ds_read_b64_tr_b16 a[172:173], v2 offset:47104
  ds_read_b64_tr_b16 a[174:175], v2 offset:47616
  s_add_u32 m0, s79, 8192
  v_mfma_f32_32x32x16_bf16 v[32:47], a[148:151], a[68:71], v[32:47]
  ds_read_b64_tr_b16 a[144:145], v2 offset:49152
  ds_read_b64_tr_b16 a[146:147], v2 offset:49664
  buffer_load_dwordx4 v10, s[28:31], s57 offen lds
  v_add_u32 v238, 128, v238
  v_mfma_f32_32x32x16_bf16 v[32:47], a[152:155], a[72:75], v[32:47]
  ds_read_b64_tr_b16 a[148:149], v2 offset:51200
  ds_read_b64_tr_b16 a[150:151], v2 offset:51712
  v_add_u32 v13, 73728, v13
  v_add_u32 v239, 73728, v239
  v_mfma_f32_32x32x16_bf16 v[32:47], a[156:159], a[76:79], v[32:47]
  ds_read_b64_tr_b16 a[152:153], v2 offset:53248
  ds_read_b64_tr_b16 a[154:155], v2 offset:53760
  buffer_load_dwordx4 v11, s[28:31], s57 offen offset:1024 lds
  s_waitcnt lgkmcnt(6)
  v_mfma_f32_32x32x16_bf16 v[32:47], a[160:163], a[80:83], v[32:47]
  ds_read_b64_tr_b16 a[156:157], v2 offset:55296
  ds_read_b64_tr_b16 a[158:159], v2 offset:55808
  s_add_u32 m0, s79, 16384
  v_mfma_f32_32x32x16_bf16 v[32:47], a[164:167], a[84:87], v[32:47]
  ds_read_b64_tr_b16 a[160:161], v2 offset:57344
  ds_read_b64_tr_b16 a[162:163], v2 offset:57856
  buffer_load_dwordx4 v10, s[28:31], s58 offen lds
  v_mfma_f32_32x32x16_bf16 v[32:47], a[168:171], a[88:91], v[32:47]
  ds_read_b64_tr_b16 a[164:165], v2 offset:59392
  ds_read_b64_tr_b16 a[166:167], v2 offset:59904
  v_mfma_f32_32x32x16_bf16 v[32:47], a[172:175], a[92:95], v[32:47]
  ds_read_b64_tr_b16 a[168:169], v2 offset:61440
  ds_read_b64_tr_b16 a[170:171], v2 offset:61952
  buffer_load_dwordx4 v11, s[28:31], s58 offen offset:1024 lds
  s_waitcnt vmcnt(24)
  s_barrier
  s_waitcnt lgkmcnt(6)
  v_mfma_f32_32x32x16_bf16 v[32:47], a[144:147], a[96:99], v[32:47]
  ds_read_b64_tr_b16 a[172:173], v2 offset:63488
  ds_read_b64_tr_b16 a[174:175], v2 offset:64000
  s_add_u32 m0, s79, 24576
  v_mfma_f32_32x32x16_bf16 v[32:47], a[148:151], a[100:103], v[32:47]
  ds_read_b64_tr_b16 a[144:145], v3 offset:0
  ds_read_b64_tr_b16 a[146:147], v3 offset:512
  buffer_load_dwordx4 v10, s[28:31], s59 offen lds
  v_mfma_f32_32x32x16_bf16 v[32:47], a[152:155], a[104:107], v[32:47]
  ds_read_b64_tr_b16 a[148:149], v3 offset:2048
  ds_read_b64_tr_b16 a[150:151], v3 offset:2560
  v_mfma_f32_32x32x16_bf16 v[32:47], a[156:159], a[108:111], v[32:47]
  ds_read_b64_tr_b16 a[152:153], v3 offset:4096
  ds_read_b64_tr_b16 a[154:155], v3 offset:4608
  buffer_load_dwordx4 v11, s[28:31], s59 offen offset:1024 lds
  ds_write_b128 v8, v[48:51]
  s_waitcnt lgkmcnt(7)
  v_mfma_f32_32x32x16_bf16 v[32:47], a[160:163], a[112:115], v[32:47]
  ds_read_b64_tr_b16 a[156:157], v3 offset:6144
  ds_read_b64_tr_b16 a[158:159], v3 offset:6656
  s_add_u32 m0, s79, 32768
  ds_write_b128 v8, v[52:55] offset:1024
  v_mfma_f32_32x32x16_bf16 v[32:47], a[164:167], a[116:119], v[32:47]
  ds_read_b64_tr_b16 a[160:161], v4 offset:0
  ds_read_b64_tr_b16 a[162:163], v4 offset:1024
  buffer_load_dwordx4 v10, s[28:31], s60 offen lds
  v_mfma_f32_32x32x16_bf16 v[32:47], a[168:171], a[120:123], v[32:47]
  ds_read_b64_tr_b16 a[164:165], v4 offset:2048
  ds_read_b64_tr_b16 a[166:167], v4 offset:3072
  v_mfma_f32_32x32x16_bf16 v[32:47], a[172:175], a[124:127], v[32:47]
  ds_read_b64_tr_b16 a[168:169], v4 offset:8192
  ds_read_b64_tr_b16 a[170:171], v4 offset:9216
  buffer_load_dwordx4 v11, s[28:31], s60 offen offset:1024 lds
  s_waitcnt lgkmcnt(6)
  v_mfma_f32_32x32x16_bf16 v[32:47], a[144:147], a[128:131], v[32:47]
  ds_read_b64_tr_b16 a[172:173], v4 offset:10240
  ds_read_b64_tr_b16 a[174:175], v4 offset:11264
  s_add_u32 m0, s79, 40960
  v_mfma_f32_32x32x16_bf16 v[32:47], a[148:151], a[132:135], v[32:47]
  ds_read_b64_tr_b16 a[144:145], v6 offset:0
  ds_read_b64_tr_b16 a[146:147], v6 offset:1024
  buffer_load_dwordx4 v10, s[28:31], s61 offen lds
  v_mfma_f32_32x32x16_bf16 v[32:47], a[152:155], a[136:139], v[32:47]
  ds_read_b64_tr_b16 a[148:149], v6 offset:2048
  ds_read_b64_tr_b16 a[150:151], v6 offset:3072
  v_mfma_f32_32x32x16_bf16 v[32:47], a[156:159], a[140:143], v[32:47]
  ds_read_b64_tr_b16 a[152:153], v6 offset:8192
  ds_read_b64_tr_b16 a[154:155], v6 offset:9216
  buffer_load_dwordx4 v11, s[28:31], s61 offen offset:1024 lds
  s_waitcnt vmcnt(24)
  s_barrier
  s_waitcnt lgkmcnt(6)
  v_mfma_f32_32x32x16_bf16 v[80:95], a[160:163], v[48:51], 0
  ds_read_b64_tr_b16 a[156:157], v6 offset:10240
  ds_read_b64_tr_b16 a[158:159], v6 offset:11264
  s_add_u32 m0, s79, 49152
  ds_read_b128 a[176:179], v9
  ds_read_b128 a[180:183], v9 offset:1024
  v_mfma_f32_32x32x16_bf16 v[80:95], a[164:167], v[52:55], v[80:95]
  ds_read_b64_tr_b16 a[160:161], v4 offset:16384
  ds_read_b64_tr_b16 a[162:163], v4 offset:17408
  buffer_load_dwordx4 v10, s[28:31], s62 offen lds
  v_mfma_f32_32x32x16_bf16 v[96:111], a[168:171], v[48:51], 0
  ds_read_b64_tr_b16 a[164:165], v4 offset:18432
  ds_read_b64_tr_b16 a[166:167], v4 offset:19456
  v_mfma_f32_32x32x16_bf16 v[96:111], a[172:175], v[52:55], v[96:111]
  ds_read_b64_tr_b16 a[168:169], v6 offset:16384
  ds_read_b64_tr_b16 a[170:171], v6 offset:17408
  buffer_load_dwordx4 v11, s[28:31], s62 offen offset:1024 lds
  s_waitcnt lgkmcnt(6)
  v_mfma_f32_32x32x16_bf16 v[80:95], a[144:147], a[176:179], v[80:95]
  ds_read_b64_tr_b16 a[172:173], v6 offset:18432
  ds_read_b64_tr_b16 a[174:175], v6 offset:19456
  s_add_u32 m0, s79, 57344
  v_exp_f32 v64, v32
  v_exp_f32 v65, v33
  v_mfma_f32_32x32x16_bf16 v[80:95], a[148:151], a[180:183], v[80:95]
  ds_read_b64_tr_b16 a[144:145], v4 offset:24576
  ds_read_b64_tr_b16 a[146:147], v4 offset:25600
  buffer_load_dwordx4 v10, s[28:31], s63 offen lds
  v_mfma_f32_32x32x16_bf16 v[96:111], a[152:155], a[176:179], v[96:111]
  ds_read_b64_tr_b16 a[148:149], v4 offset:26624
  ds_read_b64_tr_b16 a[150:151], v4 offset:27648
  v_add_f32 v64, 1.0, v64
  v_add_f32 v65, 1.0, v65
  v_mfma_f32_32x32x16_bf16 v[96:111], a[156:159], a[180:183], v[96:111]
  ds_read_b64_tr_b16 a[152:153], v6 offset:24576
  ds_read_b64_tr_b16 a[154:155], v6 offset:25600
  buffer_load_dwordx4 v11, s[28:31], s63 offen offset:1024 lds
  s_waitcnt lgkmcnt(6)
  v_mfma_f32_32x32x16_bf16 v[112:127], a[160:163], v[48:51], 0
  ds_read_b64_tr_b16 a[156:157], v6 offset:26624
  ds_read_b64_tr_b16 a[158:159], v6 offset:27648
  s_add_u32 m0, s79, 65536
  v_rcp_f32 v64, v64
  v_rcp_f32 v65, v65
  v_mfma_f32_32x32x16_bf16 v[112:127], a[164:167], v[52:55], v[112:127]
  ds_read_b64_tr_b16 a[160:161], v4 offset:32768
  ds_read_b64_tr_b16 a[162:163], v4 offset:33792
  buffer_load_dwordx4 v10, s[28:31], s64 offen lds
  v_mfma_f32_32x32x16_bf16 v[112:127], a[168:171], a[176:179], v[112:127]
  ds_read_b64_tr_b16 a[164:165], v4 offset:34816
  ds_read_b64_tr_b16 a[166:167], v4 offset:35840
  v_mul_f32 v64, v64, v32
  v_mul_f32 v65, v65, v33
  v_cvt_pk_bf16_f32 v56, v64, v65
  v_mfma_f32_32x32x16_bf16 v[112:127], a[172:175], a[180:183], v[112:127]
  ds_read_b64_tr_b16 a[168:169], v6 offset:32768
  ds_read_b64_tr_b16 a[170:171], v6 offset:33792
  buffer_load_dwordx4 v11, s[28:31], s64 offen offset:1024 lds
  s_waitcnt vmcnt(20)
  s_barrier
  s_waitcnt lgkmcnt(6)
  v_mfma_f32_32x32x16_bf16 v[128:143], a[144:147], v[48:51], 0
  ds_read_b64_tr_b16 a[172:173], v6 offset:34816
  ds_read_b64_tr_b16 a[174:175], v6 offset:35840
  s_add_u32 m0, s80, 0
  v_exp_f32 v66, v34
  v_exp_f32 v67, v35
  v_mfma_f32_32x32x16_bf16 v[128:143], a[148:151], v[52:55], v[128:143]
  ds_read_b64_tr_b16 a[144:145], v4 offset:40960
  ds_read_b64_tr_b16 a[146:147], v4 offset:41984
  buffer_load_dwordx4 v12, s[32:35], s65 offen lds
  v_mfma_f32_32x32x16_bf16 v[128:143], a[152:155], a[176:179], v[128:143]
  ds_read_b64_tr_b16 a[148:149], v4 offset:43008
  ds_read_b64_tr_b16 a[150:151], v4 offset:44032
  v_add_u32 v10, 128, v10
  v_add_f32 v66, 1.0, v66
  v_add_f32 v67, 1.0, v67
  v_mfma_f32_32x32x16_bf16 v[128:143], a[156:159], a[180:183], v[128:143]
  ds_read_b64_tr_b16 a[152:153], v6 offset:40960
  ds_read_b64_tr_b16 a[154:155], v6 offset:41984
  buffer_load_dwordx4 v13, s[32:35], s65 offen offset:1024 lds
  s_waitcnt lgkmcnt(6)
  v_mfma_f32_32x32x16_bf16 v[144:159], a[160:163], v[48:51], 0
  ds_read_b64_tr_b16 a[156:157], v6 offset:43008
  ds_read_b64_tr_b16 a[158:159], v6 offset:44032
  s_add_u32 m0, s80, 8192
  v_rcp_f32 v66, v66
  v_rcp_f32 v67, v67
  v_mfma_f32_32x32x16_bf16 v[144:159], a[164:167], v[52:55], v[144:159]
  ds_read_b64_tr_b16 a[160:161], v4 offset:49152
  ds_read_b64_tr_b16 a[162:163], v4 offset:50176
  buffer_load_dwordx4 v12, s[32:35], s66 offen lds
  v_mfma_f32_32x32x16_bf16 v[144:159], a[168:171], a[176:179], v[144:159]
  ds_read_b64_tr_b16 a[164:165], v4 offset:51200
  ds_read_b64_tr_b16 a[166:167], v4 offset:52224
  v_add_u32 v11, 128, v11
  v_mul_f32 v66, v66, v34
  v_mul_f32 v67, v67, v35
  v_cvt_pk_bf16_f32 v57, v66, v67
  v_mfma_f32_32x32x16_bf16 v[144:159], a[172:175], a[180:183], v[144:159]
  ds_read_b64_tr_b16 a[168:169], v6 offset:49152
  ds_read_b64_tr_b16 a[170:171], v6 offset:50176
  buffer_load_dwordx4 v13, s[32:35], s66 offen offset:1024 lds
  s_waitcnt lgkmcnt(6)
  v_mfma_f32_32x32x16_bf16 v[160:175], a[144:147], v[48:51], 0
  ds_read_b64_tr_b16 a[172:173], v6 offset:51200
  ds_read_b64_tr_b16 a[174:175], v6 offset:52224
  s_add_u32 m0, s80, 16384
  v_exp_f32 v68, v36
  v_exp_f32 v69, v37
  v_mfma_f32_32x32x16_bf16 v[160:175], a[148:151], v[52:55], v[160:175]
  ds_read_b64_tr_b16 a[144:145], v4 offset:57344
  ds_read_b64_tr_b16 a[146:147], v4 offset:58368
  buffer_load_dwordx4 v12, s[32:35], s67 offen lds
  v_mfma_f32_32x32x16_bf16 v[160:175], a[152:155], a[176:179], v[160:175]
  ds_read_b64_tr_b16 a[148:149], v4 offset:59392
  ds_read_b64_tr_b16 a[150:151], v4 offset:60416
  v_add_f32 v68, 1.0, v68
  v_add_f32 v69, 1.0, v69
  v_rcp_f32 v68, v68
  v_mfma_f32_32x32x16_bf16 v[160:175], a[156:159], a[180:183], v[160:175]
  ds_read_b64_tr_b16 a[152:153], v6 offset:57344
  ds_read_b64_tr_b16 a[154:155], v6 offset:58368
  buffer_load_dwordx4 v13, s[32:35], s67 offen offset:1024 lds
  s_waitcnt vmcnt(18)
  s_barrier
  s_waitcnt lgkmcnt(6)
  v_mfma_f32_32x32x16_bf16 v[176:191], a[160:163], v[48:51], 0
  ds_read_b64_tr_b16 a[156:157], v6 offset:59392
  ds_read_b64_tr_b16 a[158:159], v6 offset:60416
  s_add_u32 m0, s80, 24576
  v_rcp_f32 v69, v69
  v_mul_f32 v68, v68, v36
  v_mul_f32 v69, v69, v37
  v_mfma_f32_32x32x16_bf16 v[176:191], a[164:167], v[52:55], v[176:191]
  ds_read_b64_tr_b16 a[160:161], v5 offset:0
  ds_read_b64_tr_b16 a[162:163], v5 offset:1024
  buffer_load_dwordx4 v12, s[32:35], s68 offen lds
  v_mfma_f32_32x32x16_bf16 v[176:191], a[168:171], a[176:179], v[176:191]
  ds_read_b64_tr_b16 a[164:165], v5 offset:2048
  ds_read_b64_tr_b16 a[166:167], v5 offset:3072
  v_cvt_pk_bf16_f32 v58, v68, v69
  v_exp_f32 v70, v38
  v_mfma_f32_32x32x16_bf16 v[176:191], a[172:175], a[180:183], v[176:191]
  ds_read_b64_tr_b16 a[168:169], v7 offset:0
  ds_read_b64_tr_b16 a[170:171], v7 offset:1024
  buffer_load_dwordx4 v13, s[32:35], s68 offen offset:1024 lds
  s_waitcnt lgkmcnt(6)
  v_mfma_f32_32x32x16_bf16 v[192:207], a[144:147], v[48:51], 0
  ds_read_b64_tr_b16 a[172:173], v7 offset:2048
  ds_read_b64_tr_b16 a[174:175], v7 offset:3072
  s_add_u32 m0, s80, 32768
  v_exp_f32 v71, v39
  v_add_f32 v70, 1.0, v70
  v_add_f32 v71, 1.0, v71
  v_mfma_f32_32x32x16_bf16 v[192:207], a[148:151], v[52:55], v[192:207]
  ds_read_b64_tr_b16 a[144:145], v2 offset:0
  ds_read_b64_tr_b16 a[146:147], v2 offset:512
  buffer_load_dwordx4 v12, s[32:35], s69 offen lds
  v_mfma_f32_32x32x16_bf16 v[192:207], a[152:155], a[176:179], v[192:207]
  ds_read_b64_tr_b16 a[148:149], v2 offset:2048
  ds_read_b64_tr_b16 a[150:151], v2 offset:2560
  v_rcp_f32 v70, v70
  v_rcp_f32 v71, v71
  v_mfma_f32_32x32x16_bf16 v[192:207], a[156:159], a[180:183], v[192:207]
  ds_read_b64_tr_b16 a[152:153], v2 offset:4096
  ds_read_b64_tr_b16 a[154:155], v2 offset:4608
  buffer_load_dwordx4 v13, s[32:35], s69 offen offset:1024 lds
  s_waitcnt lgkmcnt(6)
  v_mfma_f32_32x32x16_bf16 v[208:223], a[160:163], v[48:51], 0
  ds_read_b64_tr_b16 a[156:157], v2 offset:6144
  ds_read_b64_tr_b16 a[158:159], v2 offset:6656
  s_add_u32 m0, s80, 40960
  v_mul_f32 v70, v70, v38
  v_mul_f32 v71, v71, v39
  v_cvt_pk_bf16_f32 v59, v70, v71
  v_mfma_f32_32x32x16_bf16 v[208:223], a[164:167], v[52:55], v[208:223]
  ds_read_b64_tr_b16 a[160:161], v2 offset:8192
  ds_read_b64_tr_b16 a[162:163], v2 offset:8704
  buffer_load_dwordx4 v12, s[32:35], s70 offen lds
  v_mfma_f32_32x32x16_bf16 v[208:223], a[168:171], a[176:179], v[208:223]
  ds_read_b64_tr_b16 a[164:165], v2 offset:10240
  ds_read_b64_tr_b16 a[166:167], v2 offset:10752
  v_exp_f32 v64, v40
  v_exp_f32 v65, v41
  v_mfma_f32_32x32x16_bf16 v[208:223], a[172:175], a[180:183], v[208:223]
  ds_read_b64_tr_b16 a[168:169], v2 offset:12288
  ds_read_b64_tr_b16 a[170:171], v2 offset:12800
  buffer_load_dwordx4 v13, s[32:35], s70 offen offset:1024 lds
  v_add_f32 v64, 1.0, v64
  v_add_f32 v65, 1.0, v65
  s_waitcnt vmcnt(18)
  s_barrier
  s_cmp_lg_u32 s74, 0
  s_cbranch_scc1 K1_NOSIG
  s_mov_b32 s83, 0
K1_NWS:
  v_readfirstlane_b32 s82, v253
  s_cmp_lg_u32 s82, 0
  s_cbranch_scc1 K1_NOKS
  s_add_u32 s83, s83, 1
  s_cmp_ge_u32 s83, 0x40000
  s_cbranch_scc1 K1_NOKS
  s_sleep 8
  global_load_dword v253, v252, s[20:21] sc1
  s_waitcnt vmcnt(0)
  s_branch K1_NWS
K1_NOKS:
  s_lshl_b32 s82, s78, 5
  s_add_u32 s82, s82, s77
  s_lshl_b32 s82, s82, 7
  s_add_u32 s82, s82, 31457280
  v_mov_b32 v14, 0
  s_mov_b64 exec, 1
  buffer_store_dword v253, v14, s[36:39], s82 offen sc1
  s_mov_b64 exec, -1
  s_nop 3
K1_NOSIG:
  s_mov_b32 s81, 0
.p2align 3
K1_LOOP:
  s_waitcnt lgkmcnt(6)
  v_mfma_f32_32x32x16_bf16 v[16:31], a[144:147], a[0:3], 0
  ds_read_b64_tr_b16 a[172:173], v2 offset:14336
  ds_read_b64_tr_b16 a[174:175], v2 offset:14848
  s_add_u32 m0, s80, 49152
  v_rcp_f32 v64, v64
  v_rcp_f32 v65, v65
  v_mfma_f32_32x32x16_bf16 v[16:31], a[148:151], a[4:7], v[16:31]
  ds_read_b64_tr_b16 a[144:145], v2 offset:16384
  ds_read_b64_tr_b16 a[146:147], v2 offset:16896
  buffer_load_dwordx4 v12, s[32:35], s71 offen lds
  v_mfma_f32_32x32x16_bf16 v[16:31], a[152:155], a[8:11], v[16:31]
  ds_read_b64_tr_b16 a[148:149], v2 offset:18432
  ds_read_b64_tr_b16 a[150:151], v2 offset:18944
  v_mul_f32 v64, v64, v40
  v_mul_f32 v65, v65, v41
  v_mfma_f32_32x32x16_bf16 v[16:31], a[156:159], a[12:15], v[16:31]
  ds_read_b64_tr_b16 a[152:153], v2 offset:20480
  ds_read_b64_tr_b16 a[154:155], v2 offset:20992
  buffer_load_dwordx4 v13, s[32:35], s71 offen offset:1024 lds
  s_waitcnt lgkmcnt(6)
  v_mfma_f32_32x32x16_bf16 v[16:31], a[160:163], a[16:19], v[16:31]
  ds_read_b64_tr_b16 a[156:157], v2 offset:22528
  ds_read_b64_tr_b16 a[158:159], v2 offset:23040
  s_add_u32 m0, s80, 57344
  v_cvt_pk_bf16_f32 v60, v64, v65
  v_exp_f32 v66, v42
  v_mfma_f32_32x32x16_bf16 v[16:31], a[164:167], a[20:23], v[16:31]
  ds_read_b64_tr_b16 a[160:161], v2 offset:24576
  ds_read_b64_tr_b16 a[162:163], v2 offset:25088
  buffer_load_dwordx4 v12, s[32:35], s72 offen lds
  v_mfma_f32_32x32x16_bf16 v[16:31], a[168:171], a[24:27], v[16:31]
  ds_read_b64_tr_b16 a[164:165], v2 offset:26624
  ds_read_b64_tr_b16 a[166:167], v2 offset:27136
  v_exp_f32 v67, v43
  v_add_f32 v66, 1.0, v66
  v_add_f32 v67, 1.0, v67
  v_mfma_f32_32x32x16_bf16 v[16:31], a[172:175], a[28:31], v[16:31]
  ds_read_b64_tr_b16 a[168:169], v2 offset:28672
  ds_read_b64_tr_b16 a[170:171], v2 offset:29184
  buffer_load_dwordx4 v13, s[32:35], s72 offen offset:1024 lds
  s_waitcnt lgkmcnt(6)
  v_mfma_f32_32x32x16_bf16 v[16:31], a[144:147], a[32:35], v[16:31]
  ds_read_b64_tr_b16 a[172:173], v2 offset:30720
  ds_read_b64_tr_b16 a[174:175], v2 offset:31232
  s_add_u32 m0, s80, 65536
  v_rcp_f32 v66, v66
  v_rcp_f32 v67, v67
  v_mfma_f32_32x32x16_bf16 v[16:31], a[148:151], a[36:39], v[16:31]
  ds_read_b64_tr_b16 a[144:145], v2 offset:32768
  ds_read_b64_tr_b16 a[146:147], v2 offset:33280
  buffer_load_dwordx4 v12, s[32:35], s73 offen lds
  v_mfma_f32_32x32x16_bf16 v[16:31], a[152:155], a[40:43], v[16:31]
  ds_read_b64_tr_b16 a[148:149], v2 offset:34816
  ds_read_b64_tr_b16 a[150:151], v2 offset:35328
  v_mul_f32 v66, v66, v42
  v_mul_f32 v67, v67, v43
  v_cvt_pk_bf16_f32 v61, v66, v67
  v_mfma_f32_32x32x16_bf16 v[16:31], a[156:159], a[44:47], v[16:31]
  ds_read_b64_tr_b16 a[152:153], v2 offset:36864
  ds_read_b64_tr_b16 a[154:155], v2 offset:37376
  buffer_load_dwordx4 v13, s[32:35], s73 offen offset:1024 lds
  s_waitcnt vmcnt(18)
  s_barrier
  s_waitcnt lgkmcnt(6)
  v_mfma_f32_32x32x16_bf16 v[16:31], a[160:163], a[48:51], v[16:31]
  ds_read_b64_tr_b16 a[156:157], v2 offset:38912
  ds_read_b64_tr_b16 a[158:159], v2 offset:39424
  s_add_u32 m0, s79, 0
  v_exp_f32 v68, v44
  v_exp_f32 v69, v45
  v_mfma_f32_32x32x16_bf16 v[16:31], a[164:167], a[52:55], v[16:31]
  ds_read_b64_tr_b16 a[160:161], v2 offset:40960
  ds_read_b64_tr_b16 a[162:163], v2 offset:41472
  buffer_load_dwordx4 v10, s[28:31], s56 offen lds
  buffer_load_dword v249, v238, s[28:31], 0 offen
  v_mfma_f32_32x32x16_bf16 v[16:31], a[168:171], a[56:59], v[16:31]
  ds_read_b64_tr_b16 a[164:165], v2 offset:43008
  ds_read_b64_tr_b16 a[166:167], v2 offset:43520
  v_add_u32 v12, 73728, v12
  buffer_load_dword v249, v239, s[32:35], 0 offen
  v_mfma_f32_32x32x16_bf16 v[16:31], a[172:175], a[60:63], v[16:31]
  ds_read_b64_tr_b16 a[168:169], v2 offset:45056
  ds_read_b64_tr_b16 a[170:171], v2 offset:45568
  buffer_load_dwordx4 v11, s[28:31], s56 offen offset:1024 lds
  buffer_load_dword v249, v240, s[52:55], 0 offen
  s_waitcnt lgkmcnt(6)
  v_mfma_f32_32x32x16_bf16 v[16:31], a[144:147], a[64:67], v[16:31]
  ds_read_b64_tr_b16 a[172:173], v2 offset:47104
  ds_read_b64_tr_b16 a[174:175], v2 offset:47616
  s_add_u32 m0, s79, 8192
  v_add_f32 v68, 1.0, v68
  v_add_f32 v69, 1.0, v69
  v_rcp_f32 v68, v68
  v_mfma_f32_32x32x16_bf16 v[16:31], a[148:151], a[68:71], v[16:31]
  ds_read_b64_tr_b16 a[144:145], v2 offset:49152
  ds_read_b64_tr_b16 a[146:147], v2 offset:49664
  buffer_load_dwordx4 v10, s[28:31], s57 offen lds
  v_add_u32 v238, 128, v238
  v_mfma_f32_32x32x16_bf16 v[16:31], a[152:155], a[72:75], v[16:31]
  ds_read_b64_tr_b16 a[148:149], v2 offset:51200
  ds_read_b64_tr_b16 a[150:151], v2 offset:51712
  v_add_u32 v13, 73728, v13
  v_add_u32 v239, 73728, v239
  v_rcp_f32 v69, v69
  v_mfma_f32_32x32x16_bf16 v[16:31], a[156:159], a[76:79], v[16:31]
  ds_read_b64_tr_b16 a[152:153], v2 offset:53248
  ds_read_b64_tr_b16 a[154:155], v2 offset:53760
  buffer_load_dwordx4 v11, s[28:31], s57 offen offset:1024 lds
  v_add_u32 v240, 768, v240
  s_waitcnt lgkmcnt(6)
  v_mfma_f32_32x32x16_bf16 v[16:31], a[160:163], a[80:83], v[16:31]
  ds_read_b64_tr_b16 a[156:157], v2 offset:55296
  ds_read_b64_tr_b16 a[158:159], v2 offset:55808
  s_add_u32 m0, s79, 16384
  v_mul_f32 v68, v68, v44
  v_mul_f32 v69, v69, v45
  v_cvt_pk_bf16_f32 v62, v68, v69
  v_mfma_f32_32x32x16_bf16 v[16:31], a[164:167], a[84:87], v[16:31]
  ds_read_b64_tr_b16 a[160:161], v2 offset:57344
  ds_read_b64_tr_b16 a[162:163], v2 offset:57856
  buffer_load_dwordx4 v10, s[28:31], s58 offen lds
  v_mfma_f32_32x32x16_bf16 v[16:31], a[168:171], a[88:91], v[16:31]
  ds_read_b64_tr_b16 a[164:165], v2 offset:59392
  ds_read_b64_tr_b16 a[166:167], v2 offset:59904
  v_exp_f32 v70, v46
  v_exp_f32 v71, v47
  v_mfma_f32_32x32x16_bf16 v[16:31], a[172:175], a[92:95], v[16:31]
  ds_read_b64_tr_b16 a[168:169], v2 offset:61440
  ds_read_b64_tr_b16 a[170:171], v2 offset:61952
  buffer_load_dwordx4 v11, s[28:31], s58 offen offset:1024 lds
  s_waitcnt vmcnt(21)
  s_barrier
  s_waitcnt lgkmcnt(6)
  v_mfma_f32_32x32x16_bf16 v[16:31], a[144:147], a[96:99], v[16:31]
  ds_read_b64_tr_b16 a[172:173], v2 offset:63488
  ds_read_b64_tr_b16 a[174:175], v2 offset:64000
  s_add_u32 m0, s79, 24576
  v_add_f32 v70, 1.0, v70
  v_add_f32 v71, 1.0, v71
  v_rcp_f32 v70, v70
  v_mfma_f32_32x32x16_bf16 v[16:31], a[148:151], a[100:103], v[16:31]
  ds_read_b64_tr_b16 a[144:145], v3 offset:0
  ds_read_b64_tr_b16 a[146:147], v3 offset:512
  buffer_load_dwordx4 v10, s[28:31], s59 offen lds
  v_rcp_f32 v71, v71
  v_mul_f32 v70, v70, v46
  v_mul_f32 v71, v71, v47
  v_cvt_pk_bf16_f32 v63, v70, v71
  v_mfma_f32_32x32x16_bf16 v[16:31], a[152:155], a[104:107], v[16:31]
  ds_read_b64_tr_b16 a[148:149], v3 offset:2048
  ds_read_b64_tr_b16 a[150:151], v3 offset:2560
  v_mfma_f32_32x32x16_bf16 v[16:31], a[156:159], a[108:111], v[16:31]
  ds_read_b64_tr_b16 a[152:153], v3 offset:4096
  ds_read_b64_tr_b16 a[154:155], v3 offset:4608
  buffer_load_dwordx4 v11, s[28:31], s59 offen offset:1024 lds
  ds_write_b128 v8, v[56:59]
  s_waitcnt lgkmcnt(7)
  v_mfma_f32_32x32x16_bf16 v[16:31], a[160:163], a[112:115], v[16:31]
  ds_read_b64_tr_b16 a[156:157], v3 offset:6144
  ds_read_b64_tr_b16 a[158:159], v3 offset:6656
  s_add_u32 m0, s79, 32768
  ds_write_b128 v8, v[60:63] offset:1024
  v_mfma_f32_32x32x16_bf16 v[16:31], a[164:167], a[116:119], v[16:31]
  ds_read_b64_tr_b16 a[160:161], v4 offset:0
  ds_read_b64_tr_b16 a[162:163], v4 offset:1024
  buffer_load_dwordx4 v10, s[28:31], s60 offen lds
  v_mfma_f32_32x32x16_bf16 v[16:31], a[168:171], a[120:123], v[16:31]
  ds_read_b64_tr_b16 a[164:165], v4 offset:2048
  ds_read_b64_tr_b16 a[166:167], v4 offset:3072
  v_mfma_f32_32x32x16_bf16 v[16:31], a[172:175], a[124:127], v[16:31]
  ds_read_b64_tr_b16 a[168:169], v4 offset:8192
  ds_read_b64_tr_b16 a[170:171], v4 offset:9216
  buffer_load_dwordx4 v11, s[28:31], s60 offen offset:1024 lds
  s_waitcnt lgkmcnt(6)
  v_mfma_f32_32x32x16_bf16 v[16:31], a[144:147], a[128:131], v[16:31]
  ds_read_b64_tr_b16 a[172:173], v4 offset:10240
  ds_read_b64_tr_b16 a[174:175], v4 offset:11264
  s_add_u32 m0, s79, 40960
  v_mfma_f32_32x32x16_bf16 v[16:31], a[148:151], a[132:135], v[16:31]
  ds_read_b64_tr_b16 a[144:145], v6 offset:0
  ds_read_b64_tr_b16 a[146:147], v6 offset:1024
  buffer_load_dwordx4 v10, s[28:31], s61 offen lds
  v_mfma_f32_32x32x16_bf16 v[16:31], a[152:155], a[136:139], v[16:31]
  ds_read_b64_tr_b16 a[148:149], v6 offset:2048
  ds_read_b64_tr_b16 a[150:151], v6 offset:3072
  v_mfma_f32_32x32x16_bf16 v[16:31], a[156:159], a[140:143], v[16:31]
  ds_read_b64_tr_b16 a[152:153], v6 offset:8192
  ds_read_b64_tr_b16 a[154:155], v6 offset:9216
  buffer_load_dwordx4 v11, s[28:31], s61 offen offset:1024 lds
  s_waitcnt vmcnt(21)
  s_barrier
  s_waitcnt lgkmcnt(6)
  v_mfma_f32_32x32x16_bf16 v[80:95], a[160:163], v[56:59], v[80:95]
  ds_read_b64_tr_b16 a[156:157], v6 offset:10240
  ds_read_b64_tr_b16 a[158:159], v6 offset:11264
  s_add_u32 m0, s79, 49152
  ds_read_b128 a[176:179], v9
  ds_read_b128 a[180:183], v9 offset:1024
  v_mfma_f32_32x32x16_bf16 v[80:95], a[164:167], v[60:63], v[80:95]
  ds_read_b64_tr_b16 a[160:161], v4 offset:16384
  ds_read_b64_tr_b16 a[162:163], v4 offset:17408
  buffer_load_dwordx4 v10, s[28:31], s62 offen lds
  v_mfma_f32_32x32x16_bf16 v[96:111], a[168:171], v[56:59], v[96:111]
  ds_read_b64_tr_b16 a[164:165], v4 offset:18432
  ds_read_b64_tr_b16 a[166:167], v4 offset:19456
  v_mfma_f32_32x32x16_bf16 v[96:111], a[172:175], v[60:63], v[96:111]
  ds_read_b64_tr_b16 a[168:169], v6 offset:16384
  ds_read_b64_tr_b16 a[170:171], v6 offset:17408
  buffer_load_dwordx4 v11, s[28:31], s62 offen offset:1024 lds
  s_waitcnt lgkmcnt(6)
  v_mfma_f32_32x32x16_bf16 v[80:95], a[144:147], a[176:179], v[80:95]
  ds_read_b64_tr_b16 a[172:173], v6 offset:18432
  ds_read_b64_tr_b16 a[174:175], v6 offset:19456
  s_add_u32 m0, s79, 57344
  v_exp_f32 v64, v16
  v_exp_f32 v65, v17
  v_mfma_f32_32x32x16_bf16 v[80:95], a[148:151], a[180:183], v[80:95]
  ds_read_b64_tr_b16 a[144:145], v4 offset:24576
  ds_read_b64_tr_b16 a[146:147], v4 offset:25600
  buffer_load_dwordx4 v10, s[28:31], s63 offen lds
  v_mfma_f32_32x32x16_bf16 v[96:111], a[152:155], a[176:179], v[96:111]
  ds_read_b64_tr_b16 a[148:149], v4 offset:26624
  ds_read_b64_tr_b16 a[150:151], v4 offset:27648
  v_add_f32 v64, 1.0, v64
  v_add_f32 v65, 1.0, v65
  v_mfma_f32_32x32x16_bf16 v[96:111], a[156:159], a[180:183], v[96:111]
  ds_read_b64_tr_b16 a[152:153], v6 offset:24576
  ds_read_b64_tr_b16 a[154:155], v6 offset:25600
  buffer_load_dwordx4 v11, s[28:31], s63 offen offset:1024 lds
  s_waitcnt lgkmcnt(6)
  v_mfma_f32_32x32x16_bf16 v[112:127], a[160:163], v[56:59], v[112:127]
  ds_read_b64_tr_b16 a[156:157], v6 offset:26624
  ds_read_b64_tr_b16 a[158:159], v6 offset:27648
  s_add_u32 m0, s79, 65536
  v_rcp_f32 v64, v64
  v_rcp_f32 v65, v65
  v_mfma_f32_32x32x16_bf16 v[112:127], a[164:167], v[60:63], v[112:127]
  ds_read_b64_tr_b16 a[160:161], v4 offset:32768
  ds_read_b64_tr_b16 a[162:163], v4 offset:33792
  buffer_load_dwordx4 v10, s[28:31], s64 offen lds
  v_mfma_f32_32x32x16_bf16 v[112:127], a[168:171], a[176:179], v[112:127]
  ds_read_b64_tr_b16 a[164:165], v4 offset:34816
  ds_read_b64_tr_b16 a[166:167], v4 offset:35840
  v_mul_f32 v64, v64, v16
  v_mul_f32 v65, v65, v17
  v_cvt_pk_bf16_f32 v48, v64, v65
  v_mfma_f32_32x32x16_bf16 v[112:127], a[172:175], a[180:183], v[112:127]
  ds_read_b64_tr_b16 a[168:169], v6 offset:32768
  ds_read_b64_tr_b16 a[170:171], v6 offset:33792
  buffer_load_dwordx4 v11, s[28:31], s64 offen offset:1024 lds
  s_waitcnt vmcnt(21)
  s_barrier
  s_waitcnt lgkmcnt(6)
  v_mfma_f32_32x32x16_bf16 v[128:143], a[144:147], v[56:59], v[128:143]
  ds_read_b64_tr_b16 a[172:173], v6 offset:34816
  ds_read_b64_tr_b16 a[174:175], v6 offset:35840
  s_add_u32 m0, s80, 0
  v_exp_f32 v66, v18
  v_exp_f32 v67, v19
  v_mfma_f32_32x32x16_bf16 v[128:143], a[148:151], v[60:63], v[128:143]
  ds_read_b64_tr_b16 a[144:145], v4 offset:40960
  ds_read_b64_tr_b16 a[146:147], v4 offset:41984
  buffer_load_dwordx4 v12, s[32:35], s65 offen lds
  v_mfma_f32_32x32x16_bf16 v[128:143], a[152:155], a[176:179], v[128:143]
  ds_read_b64_tr_b16 a[148:149], v4 offset:43008
  ds_read_b64_tr_b16 a[150:151], v4 offset:44032
  v_add_u32 v10, 128, v10
  v_add_f32 v66, 1.0, v66
  v_add_f32 v67, 1.0, v67
  v_mfma_f32_32x32x16_bf16 v[128:143], a[156:159], a[180:183], v[128:143]
  ds_read_b64_tr_b16 a[152:153], v6 offset:40960
  ds_read_b64_tr_b16 a[154:155], v6 offset:41984
  buffer_load_dwordx4 v13, s[32:35], s65 offen offset:1024 lds
  s_waitcnt lgkmcnt(6)
  v_mfma_f32_32x32x16_bf16 v[144:159], a[160:163], v[56:59], v[144:159]
  ds_read_b64_tr_b16 a[156:157], v6 offset:43008
  ds_read_b64_tr_b16 a[158:159], v6 offset:44032
  s_add_u32 m0, s80, 8192
  v_rcp_f32 v66, v66
  v_rcp_f32 v67, v67
  v_mfma_f32_32x32x16_bf16 v[144:159], a[164:167], v[60:63], v[144:159]
  ds_read_b64_tr_b16 a[160:161], v4 offset:49152
  ds_read_b64_tr_b16 a[162:163], v4 offset:50176
  buffer_load_dwordx4 v12, s[32:35], s66 offen lds
  v_mfma_f32_32x32x16_bf16 v[144:159], a[168:171], a[176:179], v[144:159]
  ds_read_b64_tr_b16 a[164:165], v4 offset:51200
  ds_read_b64_tr_b16 a[166:167], v4 offset:52224
  v_add_u32 v11, 128, v11
  v_mul_f32 v66, v66, v18
  v_mul_f32 v67, v67, v19
  v_cvt_pk_bf16_f32 v49, v66, v67
  v_mfma_f32_32x32x16_bf16 v[144:159], a[172:175], a[180:183], v[144:159]
  ds_read_b64_tr_b16 a[168:169], v6 offset:49152
  ds_read_b64_tr_b16 a[170:171], v6 offset:50176
  buffer_load_dwordx4 v13, s[32:35], s66 offen offset:1024 lds
  s_waitcnt lgkmcnt(6)
  v_mfma_f32_32x32x16_bf16 v[160:175], a[144:147], v[56:59], v[160:175]
  ds_read_b64_tr_b16 a[172:173], v6 offset:51200
  ds_read_b64_tr_b16 a[174:175], v6 offset:52224
  s_add_u32 m0, s80, 16384
  v_exp_f32 v68, v20
  v_exp_f32 v69, v21
  v_mfma_f32_32x32x16_bf16 v[160:175], a[148:151], v[60:63], v[160:175]
  ds_read_b64_tr_b16 a[144:145], v4 offset:57344
  ds_read_b64_tr_b16 a[146:147], v4 offset:58368
  buffer_load_dwordx4 v12, s[32:35], s67 offen lds
  v_mfma_f32_32x32x16_bf16 v[160:175], a[152:155], a[176:179], v[160:175]
  ds_read_b64_tr_b16 a[148:149], v4 offset:59392
  ds_read_b64_tr_b16 a[150:151], v4 offset:60416
  v_add_f32 v68, 1.0, v68
  v_add_f32 v69, 1.0, v69
  v_rcp_f32 v68, v68
  v_mfma_f32_32x32x16_bf16 v[160:175], a[156:159], a[180:183], v[160:175]
  ds_read_b64_tr_b16 a[152:153], v6 offset:57344
  ds_read_b64_tr_b16 a[154:155], v6 offset:58368
  buffer_load_dwordx4 v13, s[32:35], s67 offen offset:1024 lds
  s_waitcnt vmcnt(18)
  s_barrier
  s_waitcnt lgkmcnt(6)
  v_mfma_f32_32x32x16_bf16 v[176:191], a[160:163], v[56:59], v[176:191]
  ds_read_b64_tr_b16 a[156:157], v6 offset:59392
  ds_read_b64_tr_b16 a[158:159], v6 offset:60416
  s_add_u32 m0, s80, 24576
  v_rcp_f32 v69, v69
  v_mul_f32 v68, v68, v20
  v_mul_f32 v69, v69, v21
  v_mfma_f32_32x32x16_bf16 v[176:191], a[164:167], v[60:63], v[176:191]
  ds_read_b64_tr_b16 a[160:161], v5 offset:0
  ds_read_b64_tr_b16 a[162:163], v5 offset:1024
  buffer_load_dwordx4 v12, s[32:35], s68 offen lds
  v_mfma_f32_32x32x16_bf16 v[176:191], a[168:171], a[176:179], v[176:191]
  ds_read_b64_tr_b16 a[164:165], v5 offset:2048
  ds_read_b64_tr_b16 a[166:167], v5 offset:3072
  v_cvt_pk_bf16_f32 v50, v68, v69
  v_exp_f32 v70, v22
  v_mfma_f32_32x32x16_bf16 v[176:191], a[172:175], a[180:183], v[176:191]
  ds_read_b64_tr_b16 a[168:169], v7 offset:0
  ds_read_b64_tr_b16 a[170:171], v7 offset:1024
  buffer_load_dwordx4 v13, s[32:35], s68 offen offset:1024 lds
  s_waitcnt lgkmcnt(6)
  v_mfma_f32_32x32x16_bf16 v[192:207], a[144:147], v[56:59], v[192:207]
  ds_read_b64_tr_b16 a[172:173], v7 offset:2048
  ds_read_b64_tr_b16 a[174:175], v7 offset:3072
  s_add_u32 m0, s80, 32768
  v_exp_f32 v71, v23
  v_add_f32 v70, 1.0, v70
  v_add_f32 v71, 1.0, v71
  v_mfma_f32_32x32x16_bf16 v[192:207], a[148:151], v[60:63], v[192:207]
  ds_read_b64_tr_b16 a[144:145], v2 offset:0
  ds_read_b64_tr_b16 a[146:147], v2 offset:512
  buffer_load_dwordx4 v12, s[32:35], s69 offen lds
  v_mfma_f32_32x32x16_bf16 v[192:207], a[152:155], a[176:179], v[192:207]
  ds_read_b64_tr_b16 a[148:149], v2 offset:2048
  ds_read_b64_tr_b16 a[150:151], v2 offset:2560
  v_rcp_f32 v70, v70
  v_rcp_f32 v71, v71
  v_mfma_f32_32x32x16_bf16 v[192:207], a[156:159], a[180:183], v[192:207]
  ds_read_b64_tr_b16 a[152:153], v2 offset:4096
  ds_read_b64_tr_b16 a[154:155], v2 offset:4608
  buffer_load_dwordx4 v13, s[32:35], s69 offen offset:1024 lds
  s_waitcnt lgkmcnt(6)
  v_mfma_f32_32x32x16_bf16 v[208:223], a[160:163], v[56:59], v[208:223]
  ds_read_b64_tr_b16 a[156:157], v2 offset:6144
  ds_read_b64_tr_b16 a[158:159], v2 offset:6656
  s_add_u32 m0, s80, 40960
  v_mul_f32 v70, v70, v22
  v_mul_f32 v71, v71, v23
  v_cvt_pk_bf16_f32 v51, v70, v71
  v_mfma_f32_32x32x16_bf16 v[208:223], a[164:167], v[60:63], v[208:223]
  ds_read_b64_tr_b16 a[160:161], v2 offset:8192
  ds_read_b64_tr_b16 a[162:163], v2 offset:8704
  buffer_load_dwordx4 v12, s[32:35], s70 offen lds
  v_mfma_f32_32x32x16_bf16 v[208:223], a[168:171], a[176:179], v[208:223]
  ds_read_b64_tr_b16 a[164:165], v2 offset:10240
  ds_read_b64_tr_b16 a[166:167], v2 offset:10752
  v_exp_f32 v64, v24
  v_exp_f32 v65, v25
  v_mfma_f32_32x32x16_bf16 v[208:223], a[172:175], a[180:183], v[208:223]
  ds_read_b64_tr_b16 a[168:169], v2 offset:12288
  ds_read_b64_tr_b16 a[170:171], v2 offset:12800
  buffer_load_dwordx4 v13, s[32:35], s70 offen offset:1024 lds
  v_add_f32 v64, 1.0, v64
  v_add_f32 v65, 1.0, v65
  s_waitcnt vmcnt(18)
  s_barrier
  s_waitcnt lgkmcnt(6)
  v_mfma_f32_32x32x16_bf16 v[32:47], a[144:147], a[0:3], 0
  ds_read_b64_tr_b16 a[172:173], v2 offset:14336
  ds_read_b64_tr_b16 a[174:175], v2 offset:14848
  s_add_u32 m0, s80, 49152
  v_rcp_f32 v64, v64
  v_rcp_f32 v65, v65
  v_mfma_f32_32x32x16_bf16 v[32:47], a[148:151], a[4:7], v[32:47]
  ds_read_b64_tr_b16 a[144:145], v2 offset:16384
  ds_read_b64_tr_b16 a[146:147], v2 offset:16896
  buffer_load_dwordx4 v12, s[32:35], s71 offen lds
  v_mfma_f32_32x32x16_bf16 v[32:47], a[152:155], a[8:11], v[32:47]
  ds_read_b64_tr_b16 a[148:149], v2 offset:18432
  ds_read_b64_tr_b16 a[150:151], v2 offset:18944
  v_mul_f32 v64, v64, v24
  v_mul_f32 v65, v65, v25
  v_mfma_f32_32x32x16_bf16 v[32:47], a[156:159], a[12:15], v[32:47]
  ds_read_b64_tr_b16 a[152:153], v2 offset:20480
  ds_read_b64_tr_b16 a[154:155], v2 offset:20992
  buffer_load_dwordx4 v13, s[32:35], s71 offen offset:1024 lds
  s_waitcnt lgkmcnt(6)
  v_mfma_f32_32x32x16_bf16 v[32:47], a[160:163], a[16:19], v[32:47]
  ds_read_b64_tr_b16 a[156:157], v2 offset:22528
  ds_read_b64_tr_b16 a[158:159], v2 offset:23040
  s_add_u32 m0, s80, 57344
  v_cvt_pk_bf16_f32 v52, v64, v65
  v_exp_f32 v66, v26
  v_mfma_f32_32x32x16_bf16 v[32:47], a[164:167], a[20:23], v[32:47]
  ds_read_b64_tr_b16 a[160:161], v2 offset:24576
  ds_read_b64_tr_b16 a[162:163], v2 offset:25088
  buffer_load_dwordx4 v12, s[32:35], s72 offen lds
  v_mfma_f32_32x32x16_bf16 v[32:47], a[168:171], a[24:27], v[32:47]
  ds_read_b64_tr_b16 a[164:165], v2 offset:26624
  ds_read_b64_tr_b16 a[166:167], v2 offset:27136
  v_exp_f32 v67, v27
  v_add_f32 v66, 1.0, v66
  v_add_f32 v67, 1.0, v67
  v_mfma_f32_32x32x16_bf16 v[32:47], a[172:175], a[28:31], v[32:47]
  ds_read_b64_tr_b16 a[168:169], v2 offset:28672
  ds_read_b64_tr_b16 a[170:171], v2 offset:29184
  buffer_load_dwordx4 v13, s[32:35], s72 offen offset:1024 lds
  s_waitcnt lgkmcnt(6)
  v_mfma_f32_32x32x16_bf16 v[32:47], a[144:147], a[32:35], v[32:47]
  ds_read_b64_tr_b16 a[172:173], v2 offset:30720
  ds_read_b64_tr_b16 a[174:175], v2 offset:31232
  s_add_u32 m0, s80, 65536
  v_rcp_f32 v66, v66
  v_rcp_f32 v67, v67
  v_mfma_f32_32x32x16_bf16 v[32:47], a[148:151], a[36:39], v[32:47]
  ds_read_b64_tr_b16 a[144:145], v2 offset:32768
  ds_read_b64_tr_b16 a[146:147], v2 offset:33280
  buffer_load_dwordx4 v12, s[32:35], s73 offen lds
  v_mfma_f32_32x32x16_bf16 v[32:47], a[152:155], a[40:43], v[32:47]
  ds_read_b64_tr_b16 a[148:149], v2 offset:34816
  ds_read_b64_tr_b16 a[150:151], v2 offset:35328
  v_mul_f32 v66, v66, v26
  v_mul_f32 v67, v67, v27
  v_cvt_pk_bf16_f32 v53, v66, v67
  v_mfma_f32_32x32x16_bf16 v[32:47], a[156:159], a[44:47], v[32:47]
  ds_read_b64_tr_b16 a[152:153], v2 offset:36864
  ds_read_b64_tr_b16 a[154:155], v2 offset:37376
  buffer_load_dwordx4 v13, s[32:35], s73 offen offset:1024 lds
  s_waitcnt vmcnt(18)
  s_barrier
  s_waitcnt lgkmcnt(6)
  v_mfma_f32_32x32x16_bf16 v[32:47], a[160:163], a[48:51], v[32:47]
  ds_read_b64_tr_b16 a[156:157], v2 offset:38912
  ds_read_b64_tr_b16 a[158:159], v2 offset:39424
  s_add_u32 m0, s79, 0
  v_exp_f32 v68, v28
  v_exp_f32 v69, v29
  v_mfma_f32_32x32x16_bf16 v[32:47], a[164:167], a[52:55], v[32:47]
  ds_read_b64_tr_b16 a[160:161], v2 offset:40960
  ds_read_b64_tr_b16 a[162:163], v2 offset:41472
  buffer_load_dwordx4 v10, s[28:31], s56 offen lds
  buffer_load_dword v249, v238, s[28:31], 0 offen
  v_mfma_f32_32x32x16_bf16 v[32:47], a[168:171], a[56:59], v[32:47]
  ds_read_b64_tr_b16 a[164:165], v2 offset:43008
  ds_read_b64_tr_b16 a[166:167], v2 offset:43520
  v_add_u32 v12, 73728, v12
  buffer_load_dword v249, v239, s[32:35], 0 offen
  v_mfma_f32_32x32x16_bf16 v[32:47], a[172:175], a[60:63], v[32:47]
  ds_read_b64_tr_b16 a[168:169], v2 offset:45056
  ds_read_b64_tr_b16 a[170:171], v2 offset:45568
  buffer_load_dwordx4 v11, s[28:31], s56 offen offset:1024 lds
  buffer_load_dword v249, v240, s[52:55], 0 offen
  s_waitcnt lgkmcnt(6)
  v_mfma_f32_32x32x16_bf16 v[32:47], a[144:147], a[64:67], v[32:47]
  ds_read_b64_tr_b16 a[172:173], v2 offset:47104
  ds_read_b64_tr_b16 a[174:175], v2 offset:47616
  s_add_u32 m0, s79, 8192
  v_add_f32 v68, 1.0, v68
  v_add_f32 v69, 1.0, v69
  v_rcp_f32 v68, v68
  v_mfma_f32_32x32x16_bf16 v[32:47], a[148:151], a[68:71], v[32:47]
  ds_read_b64_tr_b16 a[144:145], v2 offset:49152
  ds_read_b64_tr_b16 a[146:147], v2 offset:49664
  buffer_load_dwordx4 v10, s[28:31], s57 offen lds
  v_add_u32 v238, 128, v238
  v_mfma_f32_32x32x16_bf16 v[32:47], a[152:155], a[72:75], v[32:47]
  ds_read_b64_tr_b16 a[148:149], v2 offset:51200
  ds_read_b64_tr_b16 a[150:151], v2 offset:51712
  v_add_u32 v13, 73728, v13
  v_add_u32 v239, 73728, v239
  v_rcp_f32 v69, v69
  v_mfma_f32_32x32x16_bf16 v[32:47], a[156:159], a[76:79], v[32:47]
  ds_read_b64_tr_b16 a[152:153], v2 offset:53248
  ds_read_b64_tr_b16 a[154:155], v2 offset:53760
  buffer_load_dwordx4 v11, s[28:31], s57 offen offset:1024 lds
  v_add_u32 v240, 768, v240
  s_waitcnt lgkmcnt(6)
  v_mfma_f32_32x32x16_bf16 v[32:47], a[160:163], a[80:83], v[32:47]
  ds_read_b64_tr_b16 a[156:157], v2 offset:55296
  ds_read_b64_tr_b16 a[158:159], v2 offset:55808
  s_add_u32 m0, s79, 16384
  v_mul_f32 v68, v68, v28
  v_mul_f32 v69, v69, v29
  v_cvt_pk_bf16_f32 v54, v68, v69
  v_mfma_f32_32x32x16_bf16 v[32:47], a[164:167], a[84:87], v[32:47]
  ds_read_b64_tr_b16 a[160:161], v2 offset:57344
  ds_read_b64_tr_b16 a[162:163], v2 offset:57856
  buffer_load_dwordx4 v10, s[28:31], s58 offen lds
  v_mfma_f32_32x32x16_bf16 v[32:47], a[168:171], a[88:91], v[32:47]
  ds_read_b64_tr_b16 a[164:165], v2 offset:59392
  ds_read_b64_tr_b16 a[166:167], v2 offset:59904
  v_exp_f32 v70, v30
  v_exp_f32 v71, v31
  v_mfma_f32_32x32x16_bf16 v[32:47], a[172:175], a[92:95], v[32:47]
  ds_read_b64_tr_b16 a[168:169], v2 offset:61440
  ds_read_b64_tr_b16 a[170:171], v2 offset:61952
  buffer_load_dwordx4 v11, s[28:31], s58 offen offset:1024 lds
  s_waitcnt vmcnt(21)
  s_barrier
  s_waitcnt lgkmcnt(6)
  v_mfma_f32_32x32x16_bf16 v[32:47], a[144:147], a[96:99], v[32:47]
  ds_read_b64_tr_b16 a[172:173], v2 offset:63488
  ds_read_b64_tr_b16 a[174:175], v2 offset:64000
  s_add_u32 m0, s79, 24576
  v_add_f32 v70, 1.0, v70
  v_add_f32 v71, 1.0, v71
  v_rcp_f32 v70, v70
  v_mfma_f32_32x32x16_bf16 v[32:47], a[148:151], a[100:103], v[32:47]
  ds_read_b64_tr_b16 a[144:145], v3 offset:0
  ds_read_b64_tr_b16 a[146:147], v3 offset:512
  buffer_load_dwordx4 v10, s[28:31], s59 offen lds
  v_rcp_f32 v71, v71
  v_mul_f32 v70, v70, v30
  v_mul_f32 v71, v71, v31
  v_cvt_pk_bf16_f32 v55, v70, v71
  v_mfma_f32_32x32x16_bf16 v[32:47], a[152:155], a[104:107], v[32:47]
  ds_read_b64_tr_b16 a[148:149], v3 offset:2048
  ds_read_b64_tr_b16 a[150:151], v3 offset:2560
  v_mfma_f32_32x32x16_bf16 v[32:47], a[156:159], a[108:111], v[32:47]
  ds_read_b64_tr_b16 a[152:153], v3 offset:4096
  ds_read_b64_tr_b16 a[154:155], v3 offset:4608
  buffer_load_dwordx4 v11, s[28:31], s59 offen offset:1024 lds
  ds_write_b128 v8, v[48:51]
  s_waitcnt lgkmcnt(7)
  v_mfma_f32_32x32x16_bf16 v[32:47], a[160:163], a[112:115], v[32:47]
  ds_read_b64_tr_b16 a[156:157], v3 offset:6144
  ds_read_b64_tr_b16 a[158:159], v3 offset:6656
  s_add_u32 m0, s79, 32768
  ds_write_b128 v8, v[52:55] offset:1024
  v_mfma_f32_32x32x16_bf16 v[32:47], a[164:167], a[116:119], v[32:47]
  ds_read_b64_tr_b16 a[160:161], v4 offset:0
  ds_read_b64_tr_b16 a[162:163], v4 offset:1024
  buffer_load_dwordx4 v10, s[28:31], s60 offen lds
  v_mfma_f32_32x32x16_bf16 v[32:47], a[168:171], a[120:123], v[32:47]
  ds_read_b64_tr_b16 a[164:165], v4 offset:2048
  ds_read_b64_tr_b16 a[166:167], v4 offset:3072
  v_mfma_f32_32x32x16_bf16 v[32:47], a[172:175], a[124:127], v[32:47]
  ds_read_b64_tr_b16 a[168:169], v4 offset:8192
  ds_read_b64_tr_b16 a[170:171], v4 offset:9216
  buffer_load_dwordx4 v11, s[28:31], s60 offen offset:1024 lds
  s_waitcnt lgkmcnt(6)
  v_mfma_f32_32x32x16_bf16 v[32:47], a[144:147], a[128:131], v[32:47]
  ds_read_b64_tr_b16 a[172:173], v4 offset:10240
  ds_read_b64_tr_b16 a[174:175], v4 offset:11264
  s_add_u32 m0, s79, 40960
  v_mfma_f32_32x32x16_bf16 v[32:47], a[148:151], a[132:135], v[32:47]
  ds_read_b64_tr_b16 a[144:145], v6 offset:0
  ds_read_b64_tr_b16 a[146:147], v6 offset:1024
  buffer_load_dwordx4 v10, s[28:31], s61 offen lds
  v_mfma_f32_32x32x16_bf16 v[32:47], a[152:155], a[136:139], v[32:47]
  ds_read_b64_tr_b16 a[148:149], v6 offset:2048
  ds_read_b64_tr_b16 a[150:151], v6 offset:3072
  v_mfma_f32_32x32x16_bf16 v[32:47], a[156:159], a[140:143], v[32:47]
  ds_read_b64_tr_b16 a[152:153], v6 offset:8192
  ds_read_b64_tr_b16 a[154:155], v6 offset:9216
  buffer_load_dwordx4 v11, s[28:31], s61 offen offset:1024 lds
  s_waitcnt vmcnt(21)
  s_barrier
  s_waitcnt lgkmcnt(6)
  v_mfma_f32_32x32x16_bf16 v[80:95], a[160:163], v[48:51], v[80:95]
  ds_read_b64_tr_b16 a[156:157], v6 offset:10240
  ds_read_b64_tr_b16 a[158:159], v6 offset:11264
  s_add_u32 m0, s79, 49152
  ds_read_b128 a[176:179], v9
  ds_read_b128 a[180:183], v9 offset:1024
  v_mfma_f32_32x32x16_bf16 v[80:95], a[164:167], v[52:55], v[80:95]
  ds_read_b64_tr_b16 a[160:161], v4 offset:16384
  ds_read_b64_tr_b16 a[162:163], v4 offset:17408
  buffer_load_dwordx4 v10, s[28:31], s62 offen lds
  v_mfma_f32_32x32x16_bf16 v[96:111], a[168:171], v[48:51], v[96:111]
  ds_read_b64_tr_b16 a[164:165], v4 offset:18432
  ds_read_b64_tr_b16 a[166:167], v4 offset:19456
  v_mfma_f32_32x32x16_bf16 v[96:111], a[172:175], v[52:55], v[96:111]
  ds_read_b64_tr_b16 a[168:169], v6 offset:16384
  ds_read_b64_tr_b16 a[170:171], v6 offset:17408
  buffer_load_dwordx4 v11, s[28:31], s62 offen offset:1024 lds
  s_waitcnt lgkmcnt(6)
  v_mfma_f32_32x32x16_bf16 v[80:95], a[144:147], a[176:179], v[80:95]
  ds_read_b64_tr_b16 a[172:173], v6 offset:18432
  ds_read_b64_tr_b16 a[174:175], v6 offset:19456
  s_add_u32 m0, s79, 57344
  v_exp_f32 v64, v32
  v_exp_f32 v65, v33
  v_mfma_f32_32x32x16_bf16 v[80:95], a[148:151], a[180:183], v[80:95]
  ds_read_b64_tr_b16 a[144:145], v4 offset:24576
  ds_read_b64_tr_b16 a[146:147], v4 offset:25600
  buffer_load_dwordx4 v10, s[28:31], s63 offen lds
  v_mfma_f32_32x32x16_bf16 v[96:111], a[152:155], a[176:179], v[96:111]
  ds_read_b64_tr_b16 a[148:149], v4 offset:26624
  ds_read_b64_tr_b16 a[150:151], v4 offset:27648
  v_add_f32 v64, 1.0, v64
  v_add_f32 v65, 1.0, v65
  v_mfma_f32_32x32x16_bf16 v[96:111], a[156:159], a[180:183], v[96:111]
  ds_read_b64_tr_b16 a[152:153], v6 offset:24576
  ds_read_b64_tr_b16 a[154:155], v6 offset:25600
  buffer_load_dwordx4 v11, s[28:31], s63 offen offset:1024 lds
  s_waitcnt lgkmcnt(6)
  v_mfma_f32_32x32x16_bf16 v[112:127], a[160:163], v[48:51], v[112:127]
  ds_read_b64_tr_b16 a[156:157], v6 offset:26624
  ds_read_b64_tr_b16 a[158:159], v6 offset:27648
  s_add_u32 m0, s79, 65536
  v_rcp_f32 v64, v64
  v_rcp_f32 v65, v65
  v_mfma_f32_32x32x16_bf16 v[112:127], a[164:167], v[52:55], v[112:127]
  ds_read_b64_tr_b16 a[160:161], v4 offset:32768
  ds_read_b64_tr_b16 a[162:163], v4 offset:33792
  buffer_load_dwordx4 v10, s[28:31], s64 offen lds
  v_mfma_f32_32x32x16_bf16 v[112:127], a[168:171], a[176:179], v[112:127]
  ds_read_b64_tr_b16 a[164:165], v4 offset:34816
  ds_read_b64_tr_b16 a[166:167], v4 offset:35840
  v_mul_f32 v64, v64, v32
  v_mul_f32 v65, v65, v33
  v_cvt_pk_bf16_f32 v56, v64, v65
  v_mfma_f32_32x32x16_bf16 v[112:127], a[172:175], a[180:183], v[112:127]
  ds_read_b64_tr_b16 a[168:169], v6 offset:32768
  ds_read_b64_tr_b16 a[170:171], v6 offset:33792
  buffer_load_dwordx4 v11, s[28:31], s64 offen offset:1024 lds
  s_waitcnt vmcnt(21)
  s_barrier
  s_waitcnt lgkmcnt(6)
  v_mfma_f32_32x32x16_bf16 v[128:143], a[144:147], v[48:51], v[128:143]
  ds_read_b64_tr_b16 a[172:173], v6 offset:34816
  ds_read_b64_tr_b16 a[174:175], v6 offset:35840
  s_add_u32 m0, s80, 0
  v_exp_f32 v66, v34
  v_exp_f32 v67, v35
  v_mfma_f32_32x32x16_bf16 v[128:143], a[148:151], v[52:55], v[128:143]
  ds_read_b64_tr_b16 a[144:145], v4 offset:40960
  ds_read_b64_tr_b16 a[146:147], v4 offset:41984
  buffer_load_dwordx4 v12, s[32:35], s65 offen lds
  v_mfma_f32_32x32x16_bf16 v[128:143], a[152:155], a[176:179], v[128:143]
  ds_read_b64_tr_b16 a[148:149], v4 offset:43008
  ds_read_b64_tr_b16 a[150:151], v4 offset:44032
  v_add_u32 v10, 128, v10
  v_add_f32 v66, 1.0, v66
  v_add_f32 v67, 1.0, v67
  v_mfma_f32_32x32x16_bf16 v[128:143], a[156:159], a[180:183], v[128:143]
  ds_read_b64_tr_b16 a[152:153], v6 offset:40960
  ds_read_b64_tr_b16 a[154:155], v6 offset:41984
  buffer_load_dwordx4 v13, s[32:35], s65 offen offset:1024 lds
  s_waitcnt lgkmcnt(6)
  v_mfma_f32_32x32x16_bf16 v[144:159], a[160:163], v[48:51], v[144:159]
  ds_read_b64_tr_b16 a[156:157], v6 offset:43008
  ds_read_b64_tr_b16 a[158:159], v6 offset:44032
  s_add_u32 m0, s80, 8192
  v_rcp_f32 v66, v66
  v_rcp_f32 v67, v67
  v_mfma_f32_32x32x16_bf16 v[144:159], a[164:167], v[52:55], v[144:159]
  ds_read_b64_tr_b16 a[160:161], v4 offset:49152
  ds_read_b64_tr_b16 a[162:163], v4 offset:50176
  buffer_load_dwordx4 v12, s[32:35], s66 offen lds
  v_mfma_f32_32x32x16_bf16 v[144:159], a[168:171], a[176:179], v[144:159]
  ds_read_b64_tr_b16 a[164:165], v4 offset:51200
  ds_read_b64_tr_b16 a[166:167], v4 offset:52224
  v_add_u32 v11, 128, v11
  v_mul_f32 v66, v66, v34
  v_mul_f32 v67, v67, v35
  v_cvt_pk_bf16_f32 v57, v66, v67
  v_mfma_f32_32x32x16_bf16 v[144:159], a[172:175], a[180:183], v[144:159]
  ds_read_b64_tr_b16 a[168:169], v6 offset:49152
  ds_read_b64_tr_b16 a[170:171], v6 offset:50176
  buffer_load_dwordx4 v13, s[32:35], s66 offen offset:1024 lds
  s_waitcnt lgkmcnt(6)
  v_mfma_f32_32x32x16_bf16 v[160:175], a[144:147], v[48:51], v[160:175]
  ds_read_b64_tr_b16 a[172:173], v6 offset:51200
  ds_read_b64_tr_b16 a[174:175], v6 offset:52224
  s_add_u32 m0, s80, 16384
  v_exp_f32 v68, v36
  v_exp_f32 v69, v37
  v_mfma_f32_32x32x16_bf16 v[160:175], a[148:151], v[52:55], v[160:175]
  ds_read_b64_tr_b16 a[144:145], v4 offset:57344
  ds_read_b64_tr_b16 a[146:147], v4 offset:58368
  buffer_load_dwordx4 v12, s[32:35], s67 offen lds
  v_mfma_f32_32x32x16_bf16 v[160:175], a[152:155], a[176:179], v[160:175]
  ds_read_b64_tr_b16 a[148:149], v4 offset:59392
  ds_read_b64_tr_b16 a[150:151], v4 offset:60416
  v_add_f32 v68, 1.0, v68
  v_add_f32 v69, 1.0, v69
  v_rcp_f32 v68, v68
  v_mfma_f32_32x32x16_bf16 v[160:175], a[156:159], a[180:183], v[160:175]
  ds_read_b64_tr_b16 a[152:153], v6 offset:57344
  ds_read_b64_tr_b16 a[154:155], v6 offset:58368
  buffer_load_dwordx4 v13, s[32:35], s67 offen offset:1024 lds
  s_waitcnt vmcnt(18)
  s_barrier
  s_waitcnt lgkmcnt(6)
  v_mfma_f32_32x32x16_bf16 v[176:191], a[160:163], v[48:51], v[176:191]
  ds_read_b64_tr_b16 a[156:157], v6 offset:59392
  ds_read_b64_tr_b16 a[158:159], v6 offset:60416
  s_add_u32 m0, s80, 24576
  v_rcp_f32 v69, v69
  v_mul_f32 v68, v68, v36
  v_mul_f32 v69, v69, v37
  v_mfma_f32_32x32x16_bf16 v[176:191], a[164:167], v[52:55], v[176:191]
  ds_read_b64_tr_b16 a[160:161], v5 offset:0
  ds_read_b64_tr_b16 a[162:163], v5 offset:1024
  buffer_load_dwordx4 v12, s[32:35], s68 offen lds
  v_mfma_f32_32x32x16_bf16 v[176:191], a[168:171], a[176:179], v[176:191]
  ds_read_b64_tr_b16 a[164:165], v5 offset:2048
  ds_read_b64_tr_b16 a[166:167], v5 offset:3072
  v_cvt_pk_bf16_f32 v58, v68, v69
  v_exp_f32 v70, v38
  v_mfma_f32_32x32x16_bf16 v[176:191], a[172:175], a[180:183], v[176:191]
  ds_read_b64_tr_b16 a[168:169], v7 offset:0
  ds_read_b64_tr_b16 a[170:171], v7 offset:1024
  buffer_load_dwordx4 v13, s[32:35], s68 offen offset:1024 lds
  s_waitcnt lgkmcnt(6)
  v_mfma_f32_32x32x16_bf16 v[192:207], a[144:147], v[48:51], v[192:207]
  ds_read_b64_tr_b16 a[172:173], v7 offset:2048
  ds_read_b64_tr_b16 a[174:175], v7 offset:3072
  s_add_u32 m0, s80, 32768
  v_exp_f32 v71, v39
  v_add_f32 v70, 1.0, v70
  v_add_f32 v71, 1.0, v71
  v_mfma_f32_32x32x16_bf16 v[192:207], a[148:151], v[52:55], v[192:207]
  ds_read_b64_tr_b16 a[144:145], v2 offset:0
  ds_read_b64_tr_b16 a[146:147], v2 offset:512
  buffer_load_dwordx4 v12, s[32:35], s69 offen lds
  v_mfma_f32_32x32x16_bf16 v[192:207], a[152:155], a[176:179], v[192:207]
  ds_read_b64_tr_b16 a[148:149], v2 offset:2048
  ds_read_b64_tr_b16 a[150:151], v2 offset:2560
  v_rcp_f32 v70, v70
  v_rcp_f32 v71, v71
  v_mfma_f32_32x32x16_bf16 v[192:207], a[156:159], a[180:183], v[192:207]
  ds_read_b64_tr_b16 a[152:153], v2 offset:4096
  ds_read_b64_tr_b16 a[154:155], v2 offset:4608
  buffer_load_dwordx4 v13, s[32:35], s69 offen offset:1024 lds
  s_waitcnt lgkmcnt(6)
  v_mfma_f32_32x32x16_bf16 v[208:223], a[160:163], v[48:51], v[208:223]
  ds_read_b64_tr_b16 a[156:157], v2 offset:6144
  ds_read_b64_tr_b16 a[158:159], v2 offset:6656
  s_add_u32 m0, s80, 40960
  v_mul_f32 v70, v70, v38
  v_mul_f32 v71, v71, v39
  v_cvt_pk_bf16_f32 v59, v70, v71
  v_mfma_f32_32x32x16_bf16 v[208:223], a[164:167], v[52:55], v[208:223]
  ds_read_b64_tr_b16 a[160:161], v2 offset:8192
  ds_read_b64_tr_b16 a[162:163], v2 offset:8704
  buffer_load_dwordx4 v12, s[32:35], s70 offen lds
  v_mfma_f32_32x32x16_bf16 v[208:223], a[168:171], a[176:179], v[208:223]
  ds_read_b64_tr_b16 a[164:165], v2 offset:10240
  ds_read_b64_tr_b16 a[166:167], v2 offset:10752
  v_exp_f32 v64, v40
  v_exp_f32 v65, v41
  v_mfma_f32_32x32x16_bf16 v[208:223], a[172:175], a[180:183], v[208:223]
  ds_read_b64_tr_b16 a[168:169], v2 offset:12288
  ds_read_b64_tr_b16 a[170:171], v2 offset:12800
  buffer_load_dwordx4 v13, s[32:35], s70 offen offset:1024 lds
  v_add_f32 v64, 1.0, v64
  v_add_f32 v65, 1.0, v65
  s_waitcnt vmcnt(18)
  s_barrier
  s_add_u32 s81, s81, 1
  s_cmp_lt_u32 s81, 3
  s_cbranch_scc1 K1_LOOP
  s_waitcnt lgkmcnt(6)
  v_mfma_f32_32x32x16_bf16 v[16:31], a[144:147], a[0:3], 0
  ds_read_b64_tr_b16 a[172:173], v2 offset:14336
  ds_read_b64_tr_b16 a[174:175], v2 offset:14848
  s_add_u32 m0, s80, 49152
  buffer_load_dword v255, v254, s[36:39], 0 offen sc1
  v_mfma_f32_32x32x16_bf16 v[16:31], a[148:151], a[4:7], v[16:31]
  ds_read_b64_tr_b16 a[144:145], v2 offset:16384
  ds_read_b64_tr_b16 a[146:147], v2 offset:16896
  buffer_load_dwordx4 v12, s[32:35], s71 offen lds
  s_getpc_b64 s[84:85]
K1_PC2:
  s_add_u32 s84, s84, K1_POLLED-K1_PC2
  s_addc_u32 s85, s85, 0
  v_mfma_f32_32x32x16_bf16 v[16:31], a[152:155], a[8:11], v[16:31]
  ds_read_b64_tr_b16 a[148:149], v2 offset:18432
  ds_read_b64_tr_b16 a[150:151], v2 offset:18944
  v_lshlrev_b32 v14, 7, v0
  v_rcp_f32 v64, v64
  v_mfma_f32_32x32x16_bf16 v[16:31], a[156:159], a[12:15], v[16:31]
  ds_read_b64_tr_b16 a[152:153], v2 offset:20480
  ds_read_b64_tr_b16 a[154:155], v2 offset:20992
  buffer_load_dwordx4 v13, s[32:35], s71 offen offset:1024 lds
  v_min_u32 v14, K1_END-K1_POLLED, v14
  s_waitcnt lgkmcnt(6)
  v_mfma_f32_32x32x16_bf16 v[16:31], a[160:163], a[16:19], v[16:31]
  ds_read_b64_tr_b16 a[156:157], v2 offset:22528
  ds_read_b64_tr_b16 a[158:159], v2 offset:23040
  s_add_u32 m0, s80, 57344
  global_load_dword v249, v14, s[84:85]
  v_mfma_f32_32x32x16_bf16 v[16:31], a[164:167], a[20:23], v[16:31]
  ds_read_b64_tr_b16 a[160:161], v2 offset:24576
  ds_read_b64_tr_b16 a[162:163], v2 offset:25088
  buffer_load_dwordx4 v12, s[32:35], s72 offen lds
  s_lshl_b32 s88, s2, 2
  s_add_u32 s88, s88, s74
  v_mfma_f32_32x32x16_bf16 v[16:31], a[168:171], a[24:27], v[16:31]
  ds_read_b64_tr_b16 a[164:165], v2 offset:26624
  ds_read_b64_tr_b16 a[166:167], v2 offset:27136
  s_mul_i32 s89, s74, 16640
  s_lshl_b32 s83, s88, 12
  v_rcp_f32 v65, v65
  v_mul_f32 v64, v64, v40
  v_mul_f32 v65, v65, v41
  v_mfma_f32_32x32x16_bf16 v[16:31], a[172:175], a[28:31], v[16:31]
  ds_read_b64_tr_b16 a[168:169], v2 offset:28672
  ds_read_b64_tr_b16 a[170:171], v2 offset:29184
  buffer_load_dwordx4 v13, s[32:35], s72 offen offset:1024 lds
  s_waitcnt lgkmcnt(6)
  v_mfma_f32_32x32x16_bf16 v[16:31], a[144:147], a[32:35], v[16:31]
  ds_read_b64_tr_b16 a[172:173], v2 offset:30720
  ds_read_b64_tr_b16 a[174:175], v2 offset:31232
  s_add_u32 m0, s80, 65536
  v_lshrrev_b32 v241, 2, v1
  v_cvt_pk_bf16_f32 v60, v64, v65
  v_exp_f32 v66, v42
  v_mfma_f32_32x32x16_bf16 v[16:31], a[148:151], a[36:39], v[16:31]
  ds_read_b64_tr_b16 a[144:145], v2 offset:32768
  ds_read_b64_tr_b16 a[146:147], v2 offset:33280
  buffer_load_dwordx4 v12, s[32:35], s73 offen lds
  v_mfma_f32_32x32x16_bf16 v[16:31], a[152:155], a[40:43], v[16:31]
  ds_read_b64_tr_b16 a[148:149], v2 offset:34816
  ds_read_b64_tr_b16 a[150:151], v2 offset:35328
  v_and_b32 v242, 3, v1
  v_exp_f32 v67, v43
  v_add_f32 v66, 1.0, v66
  v_mfma_f32_32x32x16_bf16 v[16:31], a[156:159], a[44:47], v[16:31]
  ds_read_b64_tr_b16 a[152:153], v2 offset:36864
  ds_read_b64_tr_b16 a[154:155], v2 offset:37376
  buffer_load_dwordx4 v13, s[32:35], s73 offen offset:1024 lds
  s_waitcnt vmcnt(20)
  s_barrier
  s_waitcnt lgkmcnt(6)
  v_mfma_f32_32x32x16_bf16 v[16:31], a[160:163], a[48:51], v[16:31]
  ds_read_b64_tr_b16 a[156:157], v2 offset:38912
  ds_read_b64_tr_b16 a[158:159], v2 offset:39424
  v_add_u32 v241, v241, v242
  v_add_f32 v67, 1.0, v67
  v_rcp_f32 v66, v66
  v_mfma_f32_32x32x16_bf16 v[16:31], a[164:167], a[52:55], v[16:31]
  ds_read_b64_tr_b16 a[160:161], v2 offset:40960
  ds_read_b64_tr_b16 a[162:163], v2 offset:41472
  v_rcp_f32 v67, v67
  v_mul_f32 v66, v66, v42
  v_mul_f32 v67, v67, v43
  v_mfma_f32_32x32x16_bf16 v[16:31], a[168:171], a[56:59], v[16:31]
  ds_read_b64_tr_b16 a[164:165], v2 offset:43008
  ds_read_b64_tr_b16 a[166:167], v2 offset:43520
  v_add_u32 v12, 73728, v12
  v_subrev_u32 v241, 16, v241
  v_cvt_pk_bf16_f32 v61, v66, v67
  v_mfma_f32_32x32x16_bf16 v[16:31], a[172:175], a[60:63], v[16:31]
  ds_read_b64_tr_b16 a[168:169], v2 offset:45056
  ds_read_b64_tr_b16 a[170:171], v2 offset:45568
  v_cmp_gt_i32 vcc, 0, v241
  v_exp_f32 v68, v44
  s_waitcnt lgkmcnt(6)
  v_mfma_f32_32x32x16_bf16 v[16:31], a[144:147], a[64:67], v[16:31]
  ds_read_b64_tr_b16 a[172:173], v2 offset:47104
  ds_read_b64_tr_b16 a[174:175], v2 offset:47616
  v_exp_f32 v69, v45
  v_add_f32 v68, 1.0, v68
  v_add_f32 v69, 1.0, v69
  v_mfma_f32_32x32x16_bf16 v[16:31], a[148:151], a[68:71], v[16:31]
  ds_read_b64_tr_b16 a[144:145], v2 offset:49152
  ds_read_b64_tr_b16 a[146:147], v2 offset:49664
  v_lshlrev_b32 v241, 2, v241
  v_rcp_f32 v68, v68
  v_mfma_f32_32x32x16_bf16 v[16:31], a[152:155], a[72:75], v[16:31]
  ds_read_b64_tr_b16 a[148:149], v2 offset:51200
  ds_read_b64_tr_b16 a[150:151], v2 offset:51712
  v_add_u32 v13, 73728, v13
  v_rcp_f32 v69, v69
  v_mul_f32 v68, v68, v44
  v_mfma_f32_32x32x16_bf16 v[16:31], a[156:159], a[76:79], v[16:31]
  ds_read_b64_tr_b16 a[152:153], v2 offset:53248
  ds_read_b64_tr_b16 a[154:155], v2 offset:53760
  v_add_u32 v241, s83, v241
  v_mul_f32 v69, v69, v45
  v_cvt_pk_bf16_f32 v62, v68, v69
  s_waitcnt lgkmcnt(6)
  v_mfma_f32_32x32x16_bf16 v[16:31], a[160:163], a[80:83], v[16:31]
  ds_read_b64_tr_b16 a[156:157], v2 offset:55296
  ds_read_b64_tr_b16 a[158:159], v2 offset:55808
  v_exp_f32 v70, v46
  v_exp_f32 v71, v47
  v_mfma_f32_32x32x16_bf16 v[16:31], a[164:167], a[84:87], v[16:31]
  ds_read_b64_tr_b16 a[160:161], v2 offset:57344
  ds_read_b64_tr_b16 a[162:163], v2 offset:57856
  v_mov_b32 v242, 0x80000000
  v_add_f32 v70, 1.0, v70
  v_add_f32 v71, 1.0, v71
  v_mfma_f32_32x32x16_bf16 v[16:31], a[168:171], a[88:91], v[16:31]
  ds_read_b64_tr_b16 a[164:165], v2 offset:59392
  ds_read_b64_tr_b16 a[166:167], v2 offset:59904
  v_rcp_f32 v70, v70
  v_rcp_f32 v71, v71
  v_mfma_f32_32x32x16_bf16 v[16:31], a[172:175], a[92:95], v[16:31]
  ds_read_b64_tr_b16 a[168:169], v2 offset:61440
  ds_read_b64_tr_b16 a[170:171], v2 offset:61952
  v_cndmask_b32 v241, v241, v242, vcc
  v_mul_f32 v70, v70, v46
  s_waitcnt vmcnt(14)
  s_barrier
  s_waitcnt lgkmcnt(6)
  v_mfma_f32_32x32x16_bf16 v[16:31], a[144:147], a[96:99], v[16:31]
  ds_read_b64_tr_b16 a[172:173], v2 offset:63488
  ds_read_b64_tr_b16 a[174:175], v2 offset:64000
  v_lshlrev_b32 v242, 2, v1
  v_mul_f32 v71, v71, v47
  v_mfma_f32_32x32x16_bf16 v[16:31], a[148:151], a[100:103], v[16:31]
  ds_read_b64_tr_b16 a[144:145], v3 offset:0
  ds_read_b64_tr_b16 a[146:147], v3 offset:512
  v_cvt_pk_bf16_f32 v63, v70, v71
  v_mfma_f32_32x32x16_bf16 v[16:31], a[152:155], a[104:107], v[16:31]
  ds_read_b64_tr_b16 a[148:149], v3 offset:2048
  ds_read_b64_tr_b16 a[150:151], v3 offset:2560
  v_add_u32 v242, s83, v242
  v_mfma_f32_32x32x16_bf16 v[16:31], a[156:159], a[108:111], v[16:31]
  ds_read_b64_tr_b16 a[152:153], v3 offset:4096
  ds_read_b64_tr_b16 a[154:155], v3 offset:4608
  ds_write_b128 v8, v[56:59]
  s_waitcnt lgkmcnt(7)
  v_mfma_f32_32x32x16_bf16 v[16:31], a[160:163], a[112:115], v[16:31]
  ds_read_b64_tr_b16 a[156:157], v3 offset:6144
  ds_read_b64_tr_b16 a[158:159], v3 offset:6656
  ds_write_b128 v8, v[60:63] offset:1024
  s_cmp_lt_u32 s2, 144
  s_cselect_b32 s83, 0, 0x80000000
  s_mul_i32 s86, s88, 4112
  s_add_u32 s86, s86, 20971520
  v_mfma_f32_32x32x16_bf16 v[16:31], a[164:167], a[116:119], v[16:31]
  ds_read_b64_tr_b16 a[160:161], v4 offset:0
  ds_read_b64_tr_b16 a[162:163], v4 offset:1024
  v_mfma_f32_32x32x16_bf16 v[16:31], a[168:171], a[120:123], v[16:31]
  ds_read_b64_tr_b16 a[164:165], v4 offset:2048
  ds_read_b64_tr_b16 a[166:167], v4 offset:3072
  v_lshlrev_b32 v243, 4, v1
  v_mfma_f32_32x32x16_bf16 v[16:31], a[172:175], a[124:127], v[16:31]
  ds_read_b64_tr_b16 a[168:169], v4 offset:8192
  ds_read_b64_tr_b16 a[170:171], v4 offset:9216
  s_waitcnt lgkmcnt(6)
  v_mfma_f32_32x32x16_bf16 v[16:31], a[144:147], a[128:131], v[16:31]
  ds_read_b64_tr_b16 a[172:173], v4 offset:10240
  ds_read_b64_tr_b16 a[174:175], v4 offset:11264
  v_add_u32 v243, s83, v243
  v_mfma_f32_32x32x16_bf16 v[16:31], a[148:151], a[132:135], v[16:31]
  ds_read_b64_tr_b16 a[144:145], v6 offset:0
  ds_read_b64_tr_b16 a[146:147], v6 offset:1024
  v_mfma_f32_32x32x16_bf16 v[16:31], a[152:155], a[136:139], v[16:31]
  ds_read_b64_tr_b16 a[148:149], v6 offset:2048
  ds_read_b64_tr_b16 a[150:151], v6 offset:3072
  v_mfma_f32_32x32x16_bf16 v[16:31], a[156:159], a[140:143], v[16:31]
  ds_read_b64_tr_b16 a[152:153], v6 offset:8192
  ds_read_b64_tr_b16 a[154:155], v6 offset:9216
  s_cmp_ge_u32 s2, 144
  s_cbranch_scc1 K1_POLLED
  s_cmp_lg_u32 s74, 0
  s_cbranch_scc1 K1_POLLED
  s_waitcnt vmcnt(7)
  s_mov_b32 s83, 0
K1_POLL:
  v_cmp_ne_u32 vcc, v253, v255
  s_nop 4
  s_cbranch_vccz K1_POLLED
  s_add_u32 s83, s83, 1
  s_cmp_ge_u32 s83, 0x40000
  s_cbranch_scc1 K1_POLLED
  s_sleep 8
  buffer_load_dword v255, v254, s[36:39], 0 offen sc1
  s_waitcnt vmcnt(0)
  s_branch K1_POLL
K1_POLLED:
  s_waitcnt vmcnt(8)
  s_barrier
  s_waitcnt lgkmcnt(6)
  v_mfma_f32_32x32x16_bf16 v[80:95], a[160:163], v[56:59], v[80:95]
  ds_read_b64_tr_b16 a[156:157], v6 offset:10240
  ds_read_b64_tr_b16 a[158:159], v6 offset:11264
  ds_read_b128 a[176:179], v9
  ds_read_b128 a[180:183], v9 offset:1024
  buffer_load_dwordx4 v[224:227], v243, s[36:39], s86 offen offset:0 sc1
  v_mfma_f32_32x32x16_bf16 v[80:95], a[164:167], v[60:63], v[80:95]
  ds_read_b64_tr_b16 a[160:161], v4 offset:16384
  ds_read_b64_tr_b16 a[162:163], v4 offset:17408
  buffer_load_dwordx4 v[228:231], v243, s[36:39], s86 offen offset:1024 sc1
  v_mfma_f32_32x32x16_bf16 v[96:111], a[168:171], v[56:59], v[96:111]
  ds_read_b64_tr_b16 a[164:165], v4 offset:18432
  ds_read_b64_tr_b16 a[166:167], v4 offset:19456
  buffer_load_dwordx4 v[232:235], v243, s[36:39], s86 offen offset:2048 sc1
  v_mfma_f32_32x32x16_bf16 v[96:111], a[172:175], v[60:63], v[96:111]
  ds_read_b64_tr_b16 a[168:169], v6 offset:16384
  ds_read_b64_tr_b16 a[170:171], v6 offset:17408
  buffer_load_dwordx4 v[236:239], v243, s[36:39], s86 offen offset:3072 sc1
  s_waitcnt lgkmcnt(6)
  v_mfma_f32_32x32x16_bf16 v[80:95], a[144:147], a[176:179], v[80:95]
  ds_read_b64_tr_b16 a[172:173], v6 offset:18432
  ds_read_b64_tr_b16 a[174:175], v6 offset:19456
  s_mov_b32 m0, s89
  s_mov_b32 s87, 0
  buffer_load_dword v241, s[52:55], 0 offen lds
  v_mfma_f32_32x32x16_bf16 v[80:95], a[148:151], a[180:183], v[80:95]
  ds_read_b64_tr_b16 a[144:145], v4 offset:24576
  ds_read_b64_tr_b16 a[146:147], v4 offset:25600
  s_add_u32 m0, s89, 256
  s_movk_i32 s87, 0
  buffer_load_dwordx4 v242, s[52:55], s87 offen lds
  v_mfma_f32_32x32x16_bf16 v[96:111], a[152:155], a[176:179], v[96:111]
  ds_read_b64_tr_b16 a[148:149], v4 offset:26624
  ds_read_b64_tr_b16 a[150:151], v4 offset:27648
  s_add_u32 m0, s89, 1280
  s_movk_i32 s87, 256
  buffer_load_dwordx4 v242, s[52:55], s87 offen lds
  v_mfma_f32_32x32x16_bf16 v[96:111], a[156:159], a[180:183], v[96:111]
  ds_read_b64_tr_b16 a[152:153], v6 offset:24576
  ds_read_b64_tr_b16 a[154:155], v6 offset:25600
  s_add_u32 m0, s89, 2304
  s_movk_i32 s87, 512
  buffer_load_dwordx4 v242, s[52:55], s87 offen lds
  s_waitcnt lgkmcnt(6)
  v_mfma_f32_32x32x16_bf16 v[112:127], a[160:163], v[56:59], v[112:127]
  ds_read_b64_tr_b16 a[156:157], v6 offset:26624
  ds_read_b64_tr_b16 a[158:159], v6 offset:27648
  s_add_u32 m0, s89, 3328
  s_movk_i32 s87, 768
  buffer_load_dwordx4 v242, s[52:55], s87 offen lds
  v_mfma_f32_32x32x16_bf16 v[112:127], a[164:167], v[60:63], v[112:127]
  ds_read_b64_tr_b16 a[160:161], v4 offset:32768
  ds_read_b64_tr_b16 a[162:163], v4 offset:33792
  s_add_u32 m0, s89, 4352
  s_movk_i32 s87, 1024
  buffer_load_dwordx4 v242, s[52:55], s87 offen lds
  v_mfma_f32_32x32x16_bf16 v[112:127], a[168:171], a[176:179], v[112:127]
  ds_read_b64_tr_b16 a[164:165], v4 offset:34816
  ds_read_b64_tr_b16 a[166:167], v4 offset:35840
  s_add_u32 m0, s89, 5376
  s_movk_i32 s87, 1280
  buffer_load_dwordx4 v242, s[52:55], s87 offen lds
  v_mfma_f32_32x32x16_bf16 v[112:127], a[172:175], a[180:183], v[112:127]
  ds_read_b64_tr_b16 a[168:169], v6 offset:32768
  ds_read_b64_tr_b16 a[170:171], v6 offset:33792
  v_exp_f32 v64, v16
  s_waitcnt vmcnt(11)
  s_barrier
  s_waitcnt lgkmcnt(6)
  v_mfma_f32_32x32x16_bf16 v[128:143], a[144:147], v[56:59], v[128:143]
  ds_read_b64_tr_b16 a[172:173], v6 offset:34816
  ds_read_b64_tr_b16 a[174:175], v6 offset:35840
  s_add_u32 m0, s80, 0
  v_exp_f32 v65, v17
  v_add_f32 v64, 1.0, v64
  v_add_f32 v65, 1.0, v65
  v_mfma_f32_32x32x16_bf16 v[128:143], a[148:151], v[60:63], v[128:143]
  ds_read_b64_tr_b16 a[144:145], v4 offset:40960
  ds_read_b64_tr_b16 a[146:147], v4 offset:41984
  buffer_load_dwordx4 v12, s[32:35], s65 offen lds
  v_mfma_f32_32x32x16_bf16 v[128:143], a[152:155], a[176:179], v[128:143]
  ds_read_b64_tr_b16 a[148:149], v4 offset:43008
  ds_read_b64_tr_b16 a[150:151], v4 offset:44032
  v_add_u32 v10, 128, v10
  v_rcp_f32 v64, v64
  v_mfma_f32_32x32x16_bf16 v[128:143], a[156:159], a[180:183], v[128:143]
  ds_read_b64_tr_b16 a[152:153], v6 offset:40960
  ds_read_b64_tr_b16 a[154:155], v6 offset:41984
  buffer_load_dwordx4 v13, s[32:35], s65 offen offset:1024 lds
  s_waitcnt lgkmcnt(6)
  v_mfma_f32_32x32x16_bf16 v[144:159], a[160:163], v[56:59], v[144:159]
  ds_read_b64_tr_b16 a[156:157], v6 offset:43008
  ds_read_b64_tr_b16 a[158:159], v6 offset:44032
  s_add_u32 m0, s80, 8192
  v_rcp_f32 v65, v65
  v_mul_f32 v64, v64, v16
  v_mul_f32 v65, v65, v17
  v_mfma_f32_32x32x16_bf16 v[144:159], a[164:167], v[60:63], v[144:159]
  ds_read_b64_tr_b16 a[160:161], v4 offset:49152
  ds_read_b64_tr_b16 a[162:163], v4 offset:50176
  buffer_load_dwordx4 v12, s[32:35], s66 offen lds
  v_mfma_f32_32x32x16_bf16 v[144:159], a[168:171], a[176:179], v[144:159]
  ds_read_b64_tr_b16 a[164:165], v4 offset:51200
  ds_read_b64_tr_b16 a[166:167], v4 offset:52224
  v_add_u32 v11, 128, v11
  v_cvt_pk_bf16_f32 v48, v64, v65
  v_exp_f32 v66, v18
  v_mfma_f32_32x32x16_bf16 v[144:159], a[172:175], a[180:183], v[144:159]
  ds_read_b64_tr_b16 a[168:169], v6 offset:49152
  ds_read_b64_tr_b16 a[170:171], v6 offset:50176
  buffer_load_dwordx4 v13, s[32:35], s66 offen offset:1024 lds
  s_waitcnt lgkmcnt(6)
  v_mfma_f32_32x32x16_bf16 v[160:175], a[144:147], v[56:59], v[160:175]
  ds_read_b64_tr_b16 a[172:173], v6 offset:51200
  ds_read_b64_tr_b16 a[174:175], v6 offset:52224
  s_add_u32 m0, s80, 16384
  v_exp_f32 v67, v19
  v_add_f32 v66, 1.0, v66
  v_add_f32 v67, 1.0, v67
  v_mfma_f32_32x32x16_bf16 v[160:175], a[148:151], v[60:63], v[160:175]
  ds_read_b64_tr_b16 a[144:145], v4 offset:57344
  ds_read_b64_tr_b16 a[146:147], v4 offset:58368
  buffer_load_dwordx4 v12, s[32:35], s67 offen lds
  v_mfma_f32_32x32x16_bf16 v[160:175], a[152:155], a[176:179], v[160:175]
  ds_read_b64_tr_b16 a[148:149], v4 offset:59392
  ds_read_b64_tr_b16 a[150:151], v4 offset:60416
  v_rcp_f32 v66, v66
  v_rcp_f32 v67, v67
  v_mfma_f32_32x32x16_bf16 v[160:175], a[156:159], a[180:183], v[160:175]
  ds_read_b64_tr_b16 a[152:153], v6 offset:57344
  ds_read_b64_tr_b16 a[154:155], v6 offset:58368
  buffer_load_dwordx4 v13, s[32:35], s67 offen offset:1024 lds
  s_barrier
  s_waitcnt lgkmcnt(6)
  v_mfma_f32_32x32x16_bf16 v[176:191], a[160:163], v[56:59], v[176:191]
  ds_read_b64_tr_b16 a[156:157], v6 offset:59392
  ds_read_b64_tr_b16 a[158:159], v6 offset:60416
  s_add_u32 m0, s80, 24576
  v_mul_f32 v66, v66, v18
  v_mul_f32 v67, v67, v19
  v_cvt_pk_bf16_f32 v49, v66, v67
  v_mfma_f32_32x32x16_bf16 v[176:191], a[164:167], v[60:63], v[176:191]
  ds_read_b64_tr_b16 a[160:161], v5 offset:0
  ds_read_b64_tr_b16 a[162:163], v5 offset:1024
  buffer_load_dwordx4 v12, s[32:35], s68 offen lds
  v_mfma_f32_32x32x16_bf16 v[176:191], a[168:171], a[176:179], v[176:191]
  ds_read_b64_tr_b16 a[164:165], v5 offset:2048
  ds_read_b64_tr_b16 a[166:167], v5 offset:3072
  v_exp_f32 v68, v20
  v_exp_f32 v69, v21
  v_mfma_f32_32x32x16_bf16 v[176:191], a[172:175], a[180:183], v[176:191]
  ds_read_b64_tr_b16 a[168:169], v7 offset:0
  ds_read_b64_tr_b16 a[170:171], v7 offset:1024
  buffer_load_dwordx4 v13, s[32:35], s68 offen offset:1024 lds
  s_waitcnt lgkmcnt(6)
  v_mfma_f32_32x32x16_bf16 v[192:207], a[144:147], v[56:59], v[192:207]
  ds_read_b64_tr_b16 a[172:173], v7 offset:2048
  ds_read_b64_tr_b16 a[174:175], v7 offset:3072
  s_add_u32 m0, s80, 32768
  v_add_f32 v68, 1.0, v68
  v_add_f32 v69, 1.0, v69
  v_rcp_f32 v68, v68
  v_mfma_f32_32x32x16_bf16 v[192:207], a[148:151], v[60:63], v[192:207]
  buffer_load_dwordx4 v12, s[32:35], s69 offen lds
  v_rcp_f32 v69, v69
  v_mfma_f32_32x32x16_bf16 v[192:207], a[152:155], a[176:179], v[192:207]
  v_mul_f32 v68, v68, v20
  v_mul_f32 v69, v69, v21
  v_cvt_pk_bf16_f32 v50, v68, v69
  v_exp_f32 v70, v22
  v_mfma_f32_32x32x16_bf16 v[192:207], a[156:159], a[180:183], v[192:207]
  buffer_load_dwordx4 v13, s[32:35], s69 offen offset:1024 lds
  v_exp_f32 v71, v23
  s_waitcnt lgkmcnt(0)
  v_mfma_f32_32x32x16_bf16 v[208:223], a[160:163], v[56:59], v[208:223]
  s_add_u32 m0, s80, 40960
  v_add_f32 v70, 1.0, v70
  v_add_f32 v71, 1.0, v71
  v_rcp_f32 v70, v70
  v_rcp_f32 v71, v71
  v_mfma_f32_32x32x16_bf16 v[208:223], a[164:167], v[60:63], v[208:223]
  buffer_load_dwordx4 v12, s[32:35], s70 offen lds
  v_mul_f32 v70, v70, v22
  v_mul_f32 v71, v71, v23
  v_mfma_f32_32x32x16_bf16 v[208:223], a[168:171], a[176:179], v[208:223]
  v_cvt_pk_bf16_f32 v51, v70, v71
  v_exp_f32 v64, v24
  v_exp_f32 v65, v25
  v_add_f32 v64, 1.0, v64
  v_mfma_f32_32x32x16_bf16 v[208:223], a[172:175], a[180:183], v[208:223]
  buffer_load_dwordx4 v13, s[32:35], s70 offen offset:1024 lds
  v_add_f32 v65, 1.0, v65
  v_rcp_f32 v64, v64
  v_rcp_f32 v65, v65
  v_mul_f32 v64, v64, v24
  v_mul_f32 v65, v65, v25
  v_cvt_pk_bf16_f32 v52, v64, v65
  v_exp_f32 v66, v26
  v_exp_f32 v67, v27
  v_add_f32 v66, 1.0, v66
  v_add_f32 v67, 1.0, v67
  v_rcp_f32 v66, v66
  v_rcp_f32 v67, v67
  v_mul_f32 v66, v66, v26
  v_mul_f32 v67, v67, v27
  v_cvt_pk_bf16_f32 v53, v66, v67
  s_barrier
  v_exp_f32 v68, v28
  v_exp_f32 v69, v29
  v_add_f32 v68, 1.0, v68
  v_add_f32 v69, 1.0, v69
  v_rcp_f32 v68, v68
  v_rcp_f32 v69, v69
  v_mul_f32 v68, v68, v28
  v_mul_f32 v69, v69, v29
  v_cvt_pk_bf16_f32 v54, v68, v69
  v_exp_f32 v70, v30
  v_exp_f32 v71, v31
  v_add_f32 v70, 1.0, v70
  v_add_f32 v71, 1.0, v71
  v_rcp_f32 v70, v70
  v_rcp_f32 v71, v71
  v_mul_f32 v70, v70, v30
  v_mul_f32 v71, v71, v31
  v_cvt_pk_bf16_f32 v55, v70, v71
  ds_write_b128 v8, v[48:51]
  ds_write_b128 v8, v[52:55] offset:1024
  s_waitcnt vmcnt(6) lgkmcnt(0)
  s_barrier
  ds_read_b128 a[176:179], v9
  ds_read_b128 a[180:183], v9 offset:1024
  ds_read_b64_tr_b16 a[144:145], v4 offset:0
  ds_read_b64_tr_b16 a[146:147], v4 offset:1024
  ds_read_b64_tr_b16 a[148:149], v4 offset:2048
  ds_read_b64_tr_b16 a[150:151], v4 offset:3072
  ds_read_b64_tr_b16 a[152:153], v4 offset:8192
  ds_read_b64_tr_b16 a[154:155], v4 offset:9216
  ds_read_b64_tr_b16 a[156:157], v4 offset:10240
  ds_read_b64_tr_b16 a[158:159], v4 offset:11264
  ds_read_b64_tr_b16 a[160:161], v6 offset:0
  ds_read_b64_tr_b16 a[162:163], v6 offset:1024
  ds_read_b64_tr_b16 a[164:165], v6 offset:2048
  ds_read_b64_tr_b16 a[166:167], v6 offset:3072
  ds_read_b64_tr_b16 a[168:169], v6 offset:8192
  ds_read_b64_tr_b16 a[170:171], v6 offset:9216
  s_waitcnt lgkmcnt(6)
  v_mfma_f32_32x32x16_bf16 v[80:95], a[144:147], v[48:51], v[80:95]
  ds_read_b64_tr_b16 a[172:173], v6 offset:10240
  ds_read_b64_tr_b16 a[174:175], v6 offset:11264
  s_add_u32 m0, s80, 49152
  s_nop 0
  buffer_load_dwordx4 v12, s[32:35], s71 offen lds
  buffer_load_dwordx4 v13, s[32:35], s71 offen offset:1024 lds
  v_mfma_f32_32x32x16_bf16 v[80:95], a[148:151], v[52:55], v[80:95]
  ds_read_b64_tr_b16 a[144:145], v4 offset:16384
  ds_read_b64_tr_b16 a[146:147], v4 offset:17408
  s_add_u32 m0, s80, 57344
  s_nop 0
  buffer_load_dwordx4 v12, s[32:35], s72 offen lds
  buffer_load_dwordx4 v13, s[32:35], s72 offen offset:1024 lds
  v_mfma_f32_32x32x16_bf16 v[96:111], a[152:155], v[48:51], v[96:111]
  ds_read_b64_tr_b16 a[148:149], v4 offset:18432
  ds_read_b64_tr_b16 a[150:151], v4 offset:19456
  s_add_u32 m0, s80, 65536
  s_nop 0
  buffer_load_dwordx4 v12, s[32:35], s73 offen lds
  buffer_load_dwordx4 v13, s[32:35], s73 offen offset:1024 lds
  v_mfma_f32_32x32x16_bf16 v[96:111], a[156:159], v[52:55], v[96:111]
  ds_read_b64_tr_b16 a[152:153], v6 offset:16384
  ds_read_b64_tr_b16 a[154:155], v6 offset:17408
  s_add_u32 m0, s89, 6400
  s_movk_i32 s87, 1536
  buffer_load_dwordx4 v242, s[52:55], s87 offen lds
  s_waitcnt lgkmcnt(6)
  v_mfma_f32_32x32x16_bf16 v[80:95], a[160:163], a[176:179], v[80:95]
  ds_read_b64_tr_b16 a[156:157], v6 offset:18432
  ds_read_b64_tr_b16 a[158:159], v6 offset:19456
  s_waitcnt vmcnt(7)
  s_barrier
  v_mfma_f32_32x32x16_bf16 v[80:95], a[164:167], a[180:183], v[80:95]
  ds_read_b64_tr_b16 a[160:161], v4 offset:24576
  ds_read_b64_tr_b16 a[162:163], v4 offset:25600
  s_add_u32 m0, s89, 7424
  s_movk_i32 s87, 1792
  buffer_load_dwordx4 v242, s[52:55], s87 offen lds
  v_mfma_f32_32x32x16_bf16 v[96:111], a[168:171], a[176:179], v[96:111]
  ds_read_b64_tr_b16 a[164:165], v4 offset:26624
  ds_read_b64_tr_b16 a[166:167], v4 offset:27648
  s_add_u32 m0, s89, 8448
  s_movk_i32 s87, 2048
  buffer_load_dwordx4 v242, s[52:55], s87 offen lds
  v_mfma_f32_32x32x16_bf16 v[96:111], a[172:175], a[180:183], v[96:111]
  ds_read_b64_tr_b16 a[168:169], v6 offset:24576
  ds_read_b64_tr_b16 a[170:171], v6 offset:25600
  s_add_u32 m0, s89, 9472
  s_movk_i32 s87, 2304
  buffer_load_dwordx4 v242, s[52:55], s87 offen lds
  s_waitcnt lgkmcnt(6)
  v_mfma_f32_32x32x16_bf16 v[112:127], a[144:147], v[48:51], v[112:127]
  ds_read_b64_tr_b16 a[172:173], v6 offset:26624
  ds_read_b64_tr_b16 a[174:175], v6 offset:27648
  s_add_u32 m0, s89, 10496
  s_movk_i32 s87, 2560
  buffer_load_dwordx4 v242, s[52:55], s87 offen lds
  v_mfma_f32_32x32x16_bf16 v[112:127], a[148:151], v[52:55], v[112:127]
  ds_read_b64_tr_b16 a[144:145], v4 offset:32768
  ds_read_b64_tr_b16 a[146:147], v4 offset:33792
  s_add_u32 m0, s89, 11520
  s_movk_i32 s87, 2816
  buffer_load_dwordx4 v242, s[52:55], s87 offen lds
  v_mfma_f32_32x32x16_bf16 v[112:127], a[152:155], a[176:179], v[112:127]
  ds_read_b64_tr_b16 a[148:149], v4 offset:34816
  ds_read_b64_tr_b16 a[150:151], v4 offset:35840
  s_add_u32 m0, s89, 12544
  s_movk_i32 s87, 3072
  buffer_load_dwordx4 v242, s[52:55], s87 offen lds
  v_mfma_f32_32x32x16_bf16 v[112:127], a[156:159], a[180:183], v[112:127]
  ds_read_b64_tr_b16 a[152:153], v6 offset:32768
  ds_read_b64_tr_b16 a[154:155], v6 offset:33792
  s_barrier
  s_waitcnt lgkmcnt(6)
  v_mfma_f32_32x32x16_bf16 v[128:143], a[160:163], v[48:51], v[128:143]
  ds_read_b64_tr_b16 a[156:157], v6 offset:34816
  ds_read_b64_tr_b16 a[158:159], v6 offset:35840
  s_add_u32 m0, s89, 13568
  s_movk_i32 s87, 3328
  buffer_load_dwordx4 v242, s[52:55], s87 offen lds
  v_mfma_f32_32x32x16_bf16 v[128:143], a[164:167], v[52:55], v[128:143]
  ds_read_b64_tr_b16 a[160:161], v4 offset:40960
  ds_read_b64_tr_b16 a[162:163], v4 offset:41984
  s_add_u32 m0, s89, 14592
  s_movk_i32 s87, 3584
  buffer_load_dwordx4 v242, s[52:55], s87 offen lds
  v_mfma_f32_32x32x16_bf16 v[128:143], a[168:171], a[176:179], v[128:143]
  ds_read_b64_tr_b16 a[164:165], v4 offset:43008
  ds_read_b64_tr_b16 a[166:167], v4 offset:44032
  s_add_u32 m0, s89, 15616
  s_movk_i32 s87, 3840
  buffer_load_dwordx4 v242, s[52:55], s87 offen lds
  v_mfma_f32_32x32x16_bf16 v[128:143], a[172:175], a[180:183], v[128:143]
  ds_read_b64_tr_b16 a[168:169], v6 offset:40960
  ds_read_b64_tr_b16 a[170:171], v6 offset:41984
  s_waitcnt lgkmcnt(6)
  v_mfma_f32_32x32x16_bf16 v[144:159], a[144:147], v[48:51], v[144:159]
  ds_read_b64_tr_b16 a[172:173], v6 offset:43008
  ds_read_b64_tr_b16 a[174:175], v6 offset:44032
  s_sub_u32 s87, s74, 1
  s_lshl_b32 s87, s87, 14
  s_add_u32 s87, s87, 73728
  s_cmp_eq_u32 s74, 0
  s_cselect_b32 s87, 147456, s87
  v_lshrrev_b32 v244, 2, v1
  v_mul_u32_u24 v244, 96, v244
  s_waitcnt vmcnt(10)
  s_barrier
  v_mfma_f32_32x32x16_bf16 v[144:159], a[148:151], v[52:55], v[144:159]
  ds_read_b64_tr_b16 a[144:145], v4 offset:49152
  ds_read_b64_tr_b16 a[146:147], v4 offset:50176
  v_and_b32 v245, 3, v1
  v_lshl_add_u32 v244, v245, 4, v244
  v_add_u32 v244, s87, v244
  v_mfma_f32_32x32x16_bf16 v[144:159], a[152:155], a[176:179], v[144:159]
  ds_read_b64_tr_b16 a[148:149], v4 offset:51200
  ds_read_b64_tr_b16 a[150:151], v4 offset:52224
  v_and_b32 v247, 15, v1
  v_lshrrev_b32 v248, 4, v1
  v_mfma_f32_32x32x16_bf16 v[144:159], a[156:159], a[180:183], v[144:159]
  ds_read_b64_tr_b16 a[152:153], v6 offset:49152
  ds_read_b64_tr_b16 a[154:155], v6 offset:50176
  v_lshlrev_b32 v245, 4, v247
  v_lshl_add_u32 v245, v248, 6, v245
  s_add_u32 s83, s89, 16
  s_waitcnt lgkmcnt(6)
  v_mfma_f32_32x32x16_bf16 v[160:175], a[160:163], v[48:51], v[160:175]
  ds_read_b64_tr_b16 a[156:157], v6 offset:51200
  ds_read_b64_tr_b16 a[158:159], v6 offset:52224
  v_add_u32 v245, s83, v245
  v_sub_u32 v246, 15, v247
  v_mul_u32_u24 v246, 96, v246
  v_mfma_f32_32x32x16_bf16 v[160:175], a[164:167], v[52:55], v[160:175]
  ds_read_b64_tr_b16 a[160:161], v4 offset:57344
  ds_read_b64_tr_b16 a[162:163], v4 offset:58368
  v_lshl_add_u32 v246, v248, 4, v246
  v_add_u32 v246, s87, v246
  v_mfma_f32_32x32x16_bf16 v[160:175], a[168:171], a[176:179], v[160:175]
  ds_read_b64_tr_b16 a[164:165], v4 offset:59392
  ds_read_b64_tr_b16 a[166:167], v4 offset:60416
  v_mov_b32 v12, 0
  v_mov_b32 v13, 0
  v_mov_b32 v14, 0
  v_mfma_f32_32x32x16_bf16 v[160:175], a[172:175], a[180:183], v[160:175]
  ds_read_b64_tr_b16 a[168:169], v6 offset:57344
  ds_read_b64_tr_b16 a[170:171], v6 offset:58368
  v_mov_b32 v15, 0
  s_lshr_b32 s83, s99, 16
  s_and_b32 s86, s99, 0xffff
  s_bitcmp1_b32 s88, 0
  s_cselect_b32 s90, s83, s86
  s_lshl_b32 s90, s90, 16
  s_barrier
  s_waitcnt lgkmcnt(6)
  v_mfma_f32_32x32x16_bf16 v[176:191], a[144:147], v[48:51], v[176:191]
  ds_read_b64_tr_b16 a[172:173], v6 offset:59392
  ds_read_b64_tr_b16 a[174:175], v6 offset:60416
  ds_write_b128 v244, v[224:227] offset:7680
  ds_write_b128 v244, v[228:231] offset:9216
  ds_write_b128 v244, v[232:235] offset:10752
  v_mfma_f32_32x32x16_bf16 v[176:191], a[148:151], v[52:55], v[176:191]
  ds_read_b64_tr_b16 a[144:145], v5 offset:0
  ds_read_b64_tr_b16 a[146:147], v5 offset:1024
  ds_write_b128 v244, v[236:239] offset:12288
  v_mov_b32_dpp v32, v224 wave_shl:1 row_mask:0xf bank_mask:0xf bound_ctrl:0
  v_mov_b32_dpp v33, v228 wave_shl:1 row_mask:0xf bank_mask:0xf bound_ctrl:0
  v_mfma_f32_32x32x16_bf16 v[176:191], a[152:155], a[176:179], v[176:191]
  ds_read_b64_tr_b16 a[148:149], v5 offset:2048
  ds_read_b64_tr_b16 a[150:151], v5 offset:3072
  v_mov_b32_dpp v34, v232 wave_shl:1 row_mask:0xf bank_mask:0xf bound_ctrl:0
  v_mov_b32_dpp v35, v236 wave_shl:1 row_mask:0xf bank_mask:0xf bound_ctrl:0
  v_readlane_b32 s83, v228, 0
  s_nop 1
  v_writelane_b32 v32, s83, 63
  v_mfma_f32_32x32x16_bf16 v[176:191], a[156:159], a[180:183], v[176:191]
  ds_read_b64_tr_b16 a[152:153], v7 offset:0
  ds_read_b64_tr_b16 a[154:155], v7 offset:1024
  v_readlane_b32 s83, v232, 0
  s_nop 1
  v_writelane_b32 v33, s83, 63
  v_readlane_b32 s83, v236, 0
  s_nop 1
  v_writelane_b32 v34, s83, 63
  s_waitcnt lgkmcnt(10)
  v_mfma_f32_32x32x16_bf16 v[192:207], a[160:163], v[48:51], v[192:207]
  ds_read_b64_tr_b16 a[156:157], v7 offset:2048
  ds_read_b64_tr_b16 a[158:159], v7 offset:3072
  v_alignbyte_b32 v16, v225, v224, 2
  v_alignbyte_b32 v17, v226, v225, 2
  v_alignbyte_b32 v18, v227, v226, 2
  v_mfma_f32_32x32x16_bf16 v[192:207], a[164:167], v[52:55], v[192:207]
  v_alignbyte_b32 v19, v32, v227, 2
  ds_write_b128 v244, v[16:19] offset:0
  v_alignbyte_b32 v20, v229, v228, 2
  v_mfma_f32_32x32x16_bf16 v[192:207], a[168:171], a[176:179], v[192:207]
  v_alignbyte_b32 v21, v230, v229, 2
  v_alignbyte_b32 v22, v231, v230, 2
  v_alignbyte_b32 v23, v33, v231, 2
  v_mfma_f32_32x32x16_bf16 v[192:207], a[172:175], a[180:183], v[192:207]
  ds_write_b128 v244, v[20:23] offset:1536
  v_alignbyte_b32 v24, v233, v232, 2
  s_waitcnt lgkmcnt(2)
  v_mfma_f32_32x32x16_bf16 v[208:223], a[144:147], v[48:51], v[208:223]
  v_alignbyte_b32 v25, v234, v233, 2
  v_alignbyte_b32 v26, v235, v234, 2
  v_alignbyte_b32 v27, v34, v235, 2
  v_mfma_f32_32x32x16_bf16 v[208:223], a[148:151], v[52:55], v[208:223]
  ds_write_b128 v244, v[24:27] offset:3072
  v_alignbyte_b32 v28, v237, v236, 2
  v_alignbyte_b32 v29, v238, v237, 2
  v_mfma_f32_32x32x16_bf16 v[208:223], a[152:155], a[176:179], v[208:223]
  v_alignbyte_b32 v30, v239, v238, 2
  v_alignbyte_b32 v31, v35, v239, 2
  ds_write_b128 v244, v[28:31] offset:4608
  v_mfma_f32_32x32x16_bf16 v[208:223], a[156:159], a[180:183], v[208:223]
  ds_write_b128 v244, v[12:15] offset:13824
  ds_write_b128 v244, v[12:15] offset:6144
  s_cmp_ge_u32 s2, 144
  s_cbranch_scc1 K1_PART_ONLY
  s_lshl_b32 s82, s77, 1
  s_add_u32 s82, s82, s75
  s_mul_i32 s82, s82, 18
  s_add_u32 s82, s82, s76
  s_lshl_b32 s82, s82, 3
  s_add_u32 s82, s82, s78
  s_lshl_b32 s82, s82, 11
  v_lshlrev_b32 v14, 4, v1
  s_waitcnt vmcnt(0) lgkmcnt(0)
  ds_read_b128 a[0:3], v245 offset:0
  ds_read_b128 a[4:7], v245 offset:4096
  ds_read_b128 a[8:11], v245 offset:8192
  ds_read_b128 a[12:15], v245 offset:12288
  ds_read_b128 a[16:19], v246 offset:4608
  ds_read_b128 a[20:23], v246 offset:12288
  ds_read_b128 a[24:27], v246 offset:3072
  ds_read_b128 a[28:31], v246 offset:10752
  ds_read_b128 a[32:35], v246 offset:1536
  ds_read_b128 a[36:39], v246 offset:9216
  ds_read_b128 a[40:43], v246 offset:0
  ds_read_b128 a[44:47], v246 offset:7680
  ds_read_b128 a[48:51], v245 offset:256
  ds_read_b128 a[52:55], v245 offset:4352
  ds_read_b128 a[56:59], v245 offset:8448
  ds_read_b128 a[60:63], v245 offset:12544
  ds_read_b128 a[64:67], v246 offset:4704
  ds_read_b128 a[68:71], v246 offset:12384
  ds_read_b128 a[72:75], v246 offset:3168
  ds_read_b128 a[76:79], v246 offset:10848
  ds_read_b128 a[80:83], v246 offset:1632
  ds_read_b128 a[84:87], v246 offset:9312
  ds_read_b128 a[88:91], v246 offset:96
  ds_read_b128 a[92:95], v246 offset:7776
  s_waitcnt lgkmcnt(12)
  v_mfma_f32_16x16x32_bf16 v[16:19], a[0:3], a[16:19], 0
  ds_read_b128 a[96:99], v245 offset:512
  v_cvt_pk_bf16_f32 v64, v80, v81
  v_mfma_f32_16x16x32_bf16 v[20:23], a[0:3], a[20:23], 0
  ds_read_b128 a[100:103], v245 offset:4608
  v_mfma_f32_16x16x32_bf16 v[24:27], a[0:3], a[24:27], 0
  v_cvt_pk_bf16_f32 v65, v82, v83
  v_mfma_f32_16x16x32_bf16 v[28:31], a[0:3], a[28:31], 0
  ds_read_b128 a[104:107], v245 offset:8704
  v_mfma_f32_16x16x32_bf16 v[32:35], a[0:3], a[32:35], 0
  ds_read_b128 a[108:111], v245 offset:12800
  v_cvt_pk_bf16_f32 v66, v84, v85
  v_mfma_f32_16x16x32_bf16 v[36:39], a[0:3], a[36:39], 0
  v_mfma_f32_16x16x32_bf16 v[40:43], a[0:3], a[40:43], 0
  ds_read_b128 a[112:115], v246 offset:4800
  v_cvt_pk_bf16_f32 v67, v86, v87
  v_mfma_f32_16x16x32_bf16 v[44:47], a[0:3], a[44:47], 0
  ds_read_b128 a[116:119], v246 offset:12480
  v_mfma_f32_16x16x32_bf16 v[24:27], a[4:7], a[16:19], v[24:27]
  v_cvt_pk_bf16_f32 v68, v88, v89
  v_mfma_f32_16x16x32_bf16 v[28:31], a[4:7], a[20:23], v[28:31]
  ds_read_b128 a[120:123], v246 offset:3264
  v_mfma_f32_16x16x32_bf16 v[32:35], a[4:7], a[24:27], v[32:35]
  ds_read_b128 a[124:127], v246 offset:10944
  v_mfma_f32_16x16x32_bf16 v[36:39], a[4:7], a[28:31], v[36:39]
  v_cvt_pk_bf16_f32 v69, v90, v91
  v_mfma_f32_16x16x32_bf16 v[40:43], a[4:7], a[32:35], v[40:43]
  ds_read_b128 a[128:131], v246 offset:1728
  v_mfma_f32_16x16x32_bf16 v[44:47], a[4:7], a[36:39], v[44:47]
  ds_read_b128 a[132:135], v246 offset:9408
  v_cvt_pk_bf16_f32 v70, v92, v93
  v_mfma_f32_16x16x32_bf16 v[32:35], a[8:11], a[16:19], v[32:35]
  v_mfma_f32_16x16x32_bf16 v[36:39], a[8:11], a[20:23], v[36:39]
  ds_read_b128 a[136:139], v246 offset:192
  v_cvt_pk_bf16_f32 v71, v94, v95
  v_mfma_f32_16x16x32_bf16 v[40:43], a[8:11], a[24:27], v[40:43]
  ds_read_b128 a[140:143], v246 offset:7872
  v_mfma_f32_16x16x32_bf16 v[44:47], a[8:11], a[28:31], v[44:47]
  v_mfma_f32_16x16x32_bf16 v[40:43], a[12:15], a[16:19], v[40:43]
  v_mfma_f32_16x16x32_bf16 v[44:47], a[12:15], a[20:23], v[44:47]
  buffer_store_dwordx4 v[64:67], v14, s[36:39], s82 offen sc1
  s_waitcnt lgkmcnt(12)
  v_mfma_f32_16x16x32_bf16 v[16:19], a[48:51], a[64:67], v[16:19]
  ds_read_b128 a[0:3], v245 offset:768
  v_mfma_f32_16x16x32_bf16 v[20:23], a[48:51], a[68:71], v[20:23]
  ds_read_b128 a[4:7], v245 offset:4864
  v_mfma_f32_16x16x32_bf16 v[24:27], a[48:51], a[72:75], v[24:27]
  v_mfma_f32_16x16x32_bf16 v[28:31], a[48:51], a[76:79], v[28:31]
  ds_read_b128 a[8:11], v245 offset:8960
  v_mfma_f32_16x16x32_bf16 v[32:35], a[48:51], a[80:83], v[32:35]
  ds_read_b128 a[12:15], v245 offset:13056
  v_mfma_f32_16x16x32_bf16 v[36:39], a[48:51], a[84:87], v[36:39]
  v_mfma_f32_16x16x32_bf16 v[40:43], a[48:51], a[88:91], v[40:43]
  ds_read_b128 a[16:19], v246 offset:4896
  v_mfma_f32_16x16x32_bf16 v[44:47], a[48:51], a[92:95], v[44:47]
  ds_read_b128 a[20:23], v246 offset:12576
  v_mfma_f32_16x16x32_bf16 v[24:27], a[52:55], a[64:67], v[24:27]
  v_mfma_f32_16x16x32_bf16 v[28:31], a[52:55], a[68:71], v[28:31]
  ds_read_b128 a[24:27], v246 offset:3360
  v_mfma_f32_16x16x32_bf16 v[32:35], a[52:55], a[72:75], v[32:35]
  ds_read_b128 a[28:31], v246 offset:11040
  v_mfma_f32_16x16x32_bf16 v[36:39], a[52:55], a[76:79], v[36:39]
  v_mfma_f32_16x16x32_bf16 v[40:43], a[52:55], a[80:83], v[40:43]
  ds_read_b128 a[32:35], v246 offset:1824
  v_mfma_f32_16x16x32_bf16 v[44:47], a[52:55], a[84:87], v[44:47]
  ds_read_b128 a[36:39], v246 offset:9504
  v_mfma_f32_16x16x32_bf16 v[32:35], a[56:59], a[64:67], v[32:35]
  v_mfma_f32_16x16x32_bf16 v[36:39], a[56:59], a[68:71], v[36:39]
  ds_read_b128 a[40:43], v246 offset:288
  v_mfma_f32_16x16x32_bf16 v[40:43], a[56:59], a[72:75], v[40:43]
  ds_read_b128 a[44:47], v246 offset:7968
  v_mfma_f32_16x16x32_bf16 v[44:47], a[56:59], a[76:79], v[44:47]
  v_mfma_f32_16x16x32_bf16 v[40:43], a[60:63], a[64:67], v[40:43]
  v_mfma_f32_16x16x32_bf16 v[44:47], a[60:63], a[68:71], v[44:47]
  buffer_store_dwordx4 v[68:71], v14, s[36:39], s82 offen offset:1024 sc1
  s_add_u32 s82, s82, 32768
  v_cvt_pk_bf16_f32 v72, v96, v97
  v_cvt_pk_bf16_f32 v73, v98, v99
  v_cvt_pk_bf16_f32 v74, v100, v101
  v_cvt_pk_bf16_f32 v75, v102, v103
  v_cvt_pk_bf16_f32 v76, v104, v105
  v_cvt_pk_bf16_f32 v77, v106, v107
  v_cvt_pk_bf16_f32 v78, v108, v109
  s_waitcnt lgkmcnt(12)
  v_mfma_f32_16x16x32_bf16 v[16:19], a[96:99], a[112:115], v[16:19]
  ds_read_b128 a[48:51], v245 offset:1024
  v_cvt_pk_bf16_f32 v79, v110, v111
  v_mfma_f32_16x16x32_bf16 v[20:23], a[96:99], a[116:119], v[20:23]
  ds_read_b128 a[52:55], v245 offset:5120
  v_mfma_f32_16x16x32_bf16 v[24:27], a[96:99], a[120:123], v[24:27]
  v_mfma_f32_16x16x32_bf16 v[28:31], a[96:99], a[124:127], v[28:31]
  ds_read_b128 a[56:59], v245 offset:9216
  v_mfma_f32_16x16x32_bf16 v[32:35], a[96:99], a[128:131], v[32:35]
  ds_read_b128 a[60:63], v245 offset:13312
  v_mfma_f32_16x16x32_bf16 v[36:39], a[96:99], a[132:135], v[36:39]
  v_mfma_f32_16x16x32_bf16 v[40:43], a[96:99], a[136:139], v[40:43]
  ds_read_b128 a[64:67], v246 offset:4992
  v_mfma_f32_16x16x32_bf16 v[44:47], a[96:99], a[140:143], v[44:47]
  ds_read_b128 a[68:71], v246 offset:12672
  v_mfma_f32_16x16x32_bf16 v[24:27], a[100:103], a[112:115], v[24:27]
  v_mfma_f32_16x16x32_bf16 v[28:31], a[100:103], a[116:119], v[28:31]
  ds_read_b128 a[72:75], v246 offset:3456
  v_mfma_f32_16x16x32_bf16 v[32:35], a[100:103], a[120:123], v[32:35]
  ds_read_b128 a[76:79], v246 offset:11136
  v_mfma_f32_16x16x32_bf16 v[36:39], a[100:103], a[124:127], v[36:39]
  v_mfma_f32_16x16x32_bf16 v[40:43], a[100:103], a[128:131], v[40:43]
  ds_read_b128 a[80:83], v246 offset:1920
  v_mfma_f32_16x16x32_bf16 v[44:47], a[100:103], a[132:135], v[44:47]
  ds_read_b128 a[84:87], v246 offset:9600
  v_mfma_f32_16x16x32_bf16 v[32:35], a[104:107], a[112:115], v[32:35]
  v_mfma_f32_16x16x32_bf16 v[36:39], a[104:107], a[116:119], v[36:39]
  ds_read_b128 a[88:91], v246 offset:384
  v_mfma_f32_16x16x32_bf16 v[40:43], a[104:107], a[120:123], v[40:43]
  ds_read_b128 a[92:95], v246 offset:8064
  v_mfma_f32_16x16x32_bf16 v[44:47], a[104:107], a[124:127], v[44:47]
  v_mfma_f32_16x16x32_bf16 v[40:43], a[108:111], a[112:115], v[40:43]
  v_mfma_f32_16x16x32_bf16 v[44:47], a[108:111], a[116:119], v[44:47]
  buffer_store_dwordx4 v[72:75], v14, s[36:39], s82 offen sc1
  buffer_store_dwordx4 v[76:79], v14, s[36:39], s82 offen offset:1024 sc1
  s_add_u32 s82, s82, 32768
  v_cvt_pk_bf16_f32 v64, v112, v113
  v_cvt_pk_bf16_f32 v65, v114, v115
  v_cvt_pk_bf16_f32 v66, v116, v117
  v_cvt_pk_bf16_f32 v67, v118, v119
  v_cvt_pk_bf16_f32 v68, v120, v121
  s_waitcnt lgkmcnt(12)
  v_mfma_f32_16x16x32_bf16 v[16:19], a[0:3], a[16:19], v[16:19]
  ds_read_b128 a[96:99], v245 offset:1280
  v_cvt_pk_bf16_f32 v69, v122, v123
  v_mfma_f32_16x16x32_bf16 v[20:23], a[0:3], a[20:23], v[20:23]
  ds_read_b128 a[100:103], v245 offset:5376
  v_mfma_f32_16x16x32_bf16 v[24:27], a[0:3], a[24:27], v[24:27]
  v_cvt_pk_bf16_f32 v70, v124, v125
  v_mfma_f32_16x16x32_bf16 v[28:31], a[0:3], a[28:31], v[28:31]
  ds_read_b128 a[104:107], v245 offset:9472
  v_mfma_f32_16x16x32_bf16 v[32:35], a[0:3], a[32:35], v[32:35]
  ds_read_b128 a[108:111], v245 offset:13568
  v_cvt_pk_bf16_f32 v71, v126, v127
  v_mfma_f32_16x16x32_bf16 v[36:39], a[0:3], a[36:39], v[36:39]
  v_mfma_f32_16x16x32_bf16 v[40:43], a[0:3], a[40:43], v[40:43]
  ds_read_b128 a[112:115], v246 offset:5088
  v_mfma_f32_16x16x32_bf16 v[44:47], a[0:3], a[44:47], v[44:47]
  ds_read_b128 a[116:119], v246 offset:12768
  v_mfma_f32_16x16x32_bf16 v[24:27], a[4:7], a[16:19], v[24:27]
  v_mfma_f32_16x16x32_bf16 v[28:31], a[4:7], a[20:23], v[28:31]
  ds_read_b128 a[120:123], v246 offset:3552
  v_mfma_f32_16x16x32_bf16 v[32:35], a[4:7], a[24:27], v[32:35]
  ds_read_b128 a[124:127], v246 offset:11232
  v_mfma_f32_16x16x32_bf16 v[36:39], a[4:7], a[28:31], v[36:39]
  v_mfma_f32_16x16x32_bf16 v[40:43], a[4:7], a[32:35], v[40:43]
  ds_read_b128 a[128:131], v246 offset:2016
  v_mfma_f32_16x16x32_bf16 v[44:47], a[4:7], a[36:39], v[44:47]
  ds_read_b128 a[132:135], v246 offset:9696
  v_mfma_f32_16x16x32_bf16 v[32:35], a[8:11], a[16:19], v[32:35]
  v_mfma_f32_16x16x32_bf16 v[36:39], a[8:11], a[20:23], v[36:39]
  ds_read_b128 a[136:139], v246 offset:480
  v_mfma_f32_16x16x32_bf16 v[40:43], a[8:11], a[24:27], v[40:43]
  ds_read_b128 a[140:143], v246 offset:8160
  v_mfma_f32_16x16x32_bf16 v[44:47], a[8:11], a[28:31], v[44:47]
  v_mfma_f32_16x16x32_bf16 v[40:43], a[12:15], a[16:19], v[40:43]
  v_mfma_f32_16x16x32_bf16 v[44:47], a[12:15], a[20:23], v[44:47]
  buffer_store_dwordx4 v[64:67], v14, s[36:39], s82 offen sc1
  buffer_store_dwordx4 v[68:71], v14, s[36:39], s82 offen offset:1024 sc1
  s_add_u32 s82, s82, 32768
  v_cvt_pk_bf16_f32 v72, v128, v129
  v_cvt_pk_bf16_f32 v73, v130, v131
  v_cvt_pk_bf16_f32 v74, v132, v133
  s_waitcnt lgkmcnt(12)
  v_mfma_f32_16x16x32_bf16 v[16:19], a[48:51], a[64:67], v[16:19]
  ds_read_b128 a[0:3], v245 offset:1536
  v_cvt_pk_bf16_f32 v75, v134, v135
  v_mfma_f32_16x16x32_bf16 v[20:23], a[48:51], a[68:71], v[20:23]
  ds_read_b128 a[4:7], v245 offset:5632
  v_mfma_f32_16x16x32_bf16 v[24:27], a[48:51], a[72:75], v[24:27]
  v_cvt_pk_bf16_f32 v76, v136, v137
  v_mfma_f32_16x16x32_bf16 v[28:31], a[48:51], a[76:79], v[28:31]
  ds_read_b128 a[8:11], v245 offset:9728
  v_mfma_f32_16x16x32_bf16 v[32:35], a[48:51], a[80:83], v[32:35]
  ds_read_b128 a[12:15], v245 offset:13824
  v_cvt_pk_bf16_f32 v77, v138, v139
  v_mfma_f32_16x16x32_bf16 v[36:39], a[48:51], a[84:87], v[36:39]
  v_mfma_f32_16x16x32_bf16 v[40:43], a[48:51], a[88:91], v[40:43]
  ds_read_b128 a[16:19], v246 offset:5184
  v_cvt_pk_bf16_f32 v78, v140, v141
  v_mfma_f32_16x16x32_bf16 v[44:47], a[48:51], a[92:95], v[44:47]
  ds_read_b128 a[20:23], v246 offset:12864
  v_mfma_f32_16x16x32_bf16 v[24:27], a[52:55], a[64:67], v[24:27]
  v_cvt_pk_bf16_f32 v79, v142, v143
  v_mfma_f32_16x16x32_bf16 v[28:31], a[52:55], a[68:71], v[28:31]
  ds_read_b128 a[24:27], v246 offset:3648
  v_mfma_f32_16x16x32_bf16 v[32:35], a[52:55], a[72:75], v[32:35]
  ds_read_b128 a[28:31], v246 offset:11328
  v_mfma_f32_16x16x32_bf16 v[36:39], a[52:55], a[76:79], v[36:39]
  v_mfma_f32_16x16x32_bf16 v[40:43], a[52:55], a[80:83], v[40:43]
  ds_read_b128 a[32:35], v246 offset:2112
  v_mfma_f32_16x16x32_bf16 v[44:47], a[52:55], a[84:87], v[44:47]
  ds_read_b128 a[36:39], v246 offset:9792
  v_mfma_f32_16x16x32_bf16 v[32:35], a[56:59], a[64:67], v[32:35]
  v_mfma_f32_16x16x32_bf16 v[36:39], a[56:59], a[68:71], v[36:39]
  ds_read_b128 a[40:43], v246 offset:576
  v_mfma_f32_16x16x32_bf16 v[40:43], a[56:59], a[72:75], v[40:43]
  ds_read_b128 a[44:47], v246 offset:8256
  v_mfma_f32_16x16x32_bf16 v[44:47], a[56:59], a[76:79], v[44:47]
  v_mfma_f32_16x16x32_bf16 v[40:43], a[60:63], a[64:67], v[40:43]
  v_mfma_f32_16x16x32_bf16 v[44:47], a[60:63], a[68:71], v[44:47]
  buffer_store_dwordx4 v[72:75], v14, s[36:39], s82 offen sc1
  buffer_store_dwordx4 v[76:79], v14, s[36:39], s82 offen offset:1024 sc1
  s_add_u32 s82, s82, 32768
  v_cvt_pk_bf16_f32 v64, v144, v145
  s_waitcnt lgkmcnt(12)
  v_mfma_f32_16x16x32_bf16 v[16:19], a[96:99], a[112:115], v[16:19]
  ds_read_b128 a[48:51], v245 offset:1792
  v_cvt_pk_bf16_f32 v65, v146, v147
  v_mfma_f32_16x16x32_bf16 v[20:23], a[96:99], a[116:119], v[20:23]
  ds_read_b128 a[52:55], v245 offset:5888
  v_mfma_f32_16x16x32_bf16 v[24:27], a[96:99], a[120:123], v[24:27]
  v_cvt_pk_bf16_f32 v66, v148, v149
  v_mfma_f32_16x16x32_bf16 v[28:31], a[96:99], a[124:127], v[28:31]
  ds_read_b128 a[56:59], v245 offset:9984
  v_mfma_f32_16x16x32_bf16 v[32:35], a[96:99], a[128:131], v[32:35]
  ds_read_b128 a[60:63], v245 offset:14080
  v_cvt_pk_bf16_f32 v67, v150, v151
  v_mfma_f32_16x16x32_bf16 v[36:39], a[96:99], a[132:135], v[36:39]
  v_mfma_f32_16x16x32_bf16 v[40:43], a[96:99], a[136:139], v[40:43]
  ds_read_b128 a[64:67], v246 offset:5280
  v_cvt_pk_bf16_f32 v68, v152, v153
  v_mfma_f32_16x16x32_bf16 v[44:47], a[96:99], a[140:143], v[44:47]
  ds_read_b128 a[68:71], v246 offset:12960
  v_mfma_f32_16x16x32_bf16 v[24:27], a[100:103], a[112:115], v[24:27]
  v_cvt_pk_bf16_f32 v69, v154, v155
  v_mfma_f32_16x16x32_bf16 v[28:31], a[100:103], a[116:119], v[28:31]
  ds_read_b128 a[72:75], v246 offset:3744
  v_mfma_f32_16x16x32_bf16 v[32:35], a[100:103], a[120:123], v[32:35]
  ds_read_b128 a[76:79], v246 offset:11424
  v_mfma_f32_16x16x32_bf16 v[36:39], a[100:103], a[124:127], v[36:39]
  v_cvt_pk_bf16_f32 v70, v156, v157
  v_mfma_f32_16x16x32_bf16 v[40:43], a[100:103], a[128:131], v[40:43]
  ds_read_b128 a[80:83], v246 offset:2208
  v_mfma_f32_16x16x32_bf16 v[44:47], a[100:103], a[132:135], v[44:47]
  ds_read_b128 a[84:87], v246 offset:9888
  v_cvt_pk_bf16_f32 v71, v158, v159
  v_mfma_f32_16x16x32_bf16 v[32:35], a[104:107], a[112:115], v[32:35]
  v_mfma_f32_16x16x32_bf16 v[36:39], a[104:107], a[116:119], v[36:39]
  ds_read_b128 a[88:91], v246 offset:672
  v_mfma_f32_16x16x32_bf16 v[40:43], a[104:107], a[120:123], v[40:43]
  ds_read_b128 a[92:95], v246 offset:8352
  v_mfma_f32_16x16x32_bf16 v[44:47], a[104:107], a[124:127], v[44:47]
  v_mfma_f32_16x16x32_bf16 v[40:43], a[108:111], a[112:115], v[40:43]
  v_mfma_f32_16x16x32_bf16 v[44:47], a[108:111], a[116:119], v[44:47]
  buffer_store_dwordx4 v[64:67], v14, s[36:39], s82 offen sc1
  buffer_store_dwordx4 v[68:71], v14, s[36:39], s82 offen offset:1024 sc1
  s_waitcnt lgkmcnt(12)
  v_mfma_f32_16x16x32_bf16 v[16:19], a[0:3], a[16:19], v[16:19]
  ds_read_b128 a[96:99], v245 offset:2048
  s_add_u32 s82, s82, 32768
  v_mfma_f32_16x16x32_bf16 v[20:23], a[0:3], a[20:23], v[20:23]
  ds_read_b128 a[100:103], v245 offset:6144
  v_mfma_f32_16x16x32_bf16 v[24:27], a[0:3], a[24:27], v[24:27]
  v_cvt_pk_bf16_f32 v72, v160, v161
  v_mfma_f32_16x16x32_bf16 v[28:31], a[0:3], a[28:31], v[28:31]
  ds_read_b128 a[104:107], v245 offset:10240
  v_mfma_f32_16x16x32_bf16 v[32:35], a[0:3], a[32:35], v[32:35]
  ds_read_b128 a[108:111], v245 offset:14336
  v_cvt_pk_bf16_f32 v73, v162, v163
  v_mfma_f32_16x16x32_bf16 v[36:39], a[0:3], a[36:39], v[36:39]
  v_mfma_f32_16x16x32_bf16 v[40:43], a[0:3], a[40:43], v[40:43]
  ds_read_b128 a[112:115], v246 offset:5376
  v_cvt_pk_bf16_f32 v74, v164, v165
  v_mfma_f32_16x16x32_bf16 v[44:47], a[0:3], a[44:47], v[44:47]
  ds_read_b128 a[116:119], v246 offset:13056
  v_mfma_f32_16x16x32_bf16 v[24:27], a[4:7], a[16:19], v[24:27]
  v_cvt_pk_bf16_f32 v75, v166, v167
  v_mfma_f32_16x16x32_bf16 v[28:31], a[4:7], a[20:23], v[28:31]
  ds_read_b128 a[120:123], v246 offset:3840
  v_mfma_f32_16x16x32_bf16 v[32:35], a[4:7], a[24:27], v[32:35]
  ds_read_b128 a[124:127], v246 offset:11520
  v_mfma_f32_16x16x32_bf16 v[36:39], a[4:7], a[28:31], v[36:39]
  v_cvt_pk_bf16_f32 v76, v168, v169
  v_mfma_f32_16x16x32_bf16 v[40:43], a[4:7], a[32:35], v[40:43]
  ds_read_b128 a[128:131], v246 offset:2304
  v_mfma_f32_16x16x32_bf16 v[44:47], a[4:7], a[36:39], v[44:47]
  ds_read_b128 a[132:135], v246 offset:9984
  v_cvt_pk_bf16_f32 v77, v170, v171
  v_mfma_f32_16x16x32_bf16 v[32:35], a[8:11], a[16:19], v[32:35]
  v_mfma_f32_16x16x32_bf16 v[36:39], a[8:11], a[20:23], v[36:39]
  ds_read_b128 a[136:139], v246 offset:768
  v_cvt_pk_bf16_f32 v78, v172, v173
  v_mfma_f32_16x16x32_bf16 v[40:43], a[8:11], a[24:27], v[40:43]
  ds_read_b128 a[140:143], v246 offset:8448
  v_mfma_f32_16x16x32_bf16 v[44:47], a[8:11], a[28:31], v[44:47]
  v_cvt_pk_bf16_f32 v79, v174, v175
  v_mfma_f32_16x16x32_bf16 v[40:43], a[12:15], a[16:19], v[40:43]
  v_mfma_f32_16x16x32_bf16 v[44:47], a[12:15], a[20:23], v[44:47]
  s_waitcnt lgkmcnt(12)
  v_mfma_f32_16x16x32_bf16 v[16:19], a[48:51], a[64:67], v[16:19]
  ds_read_b128 a[0:3], v245 offset:2304
  v_mfma_f32_16x16x32_bf16 v[20:23], a[48:51], a[68:71], v[20:23]
  ds_read_b128 a[4:7], v245 offset:6400
  v_mfma_f32_16x16x32_bf16 v[24:27], a[48:51], a[72:75], v[24:27]
  v_mfma_f32_16x16x32_bf16 v[28:31], a[48:51], a[76:79], v[28:31]
  ds_read_b128 a[8:11], v245 offset:10496
  v_mfma_f32_16x16x32_bf16 v[32:35], a[48:51], a[80:83], v[32:35]
  ds_read_b128 a[12:15], v245 offset:14592
  v_mfma_f32_16x16x32_bf16 v[36:39], a[48:51], a[84:87], v[36:39]
  v_mfma_f32_16x16x32_bf16 v[40:43], a[48:51], a[88:91], v[40:43]
  ds_read_b128 a[16:19], v246 offset:5472
  v_mfma_f32_16x16x32_bf16 v[44:47], a[48:51], a[92:95], v[44:47]
  ds_read_b128 a[20:23], v246 offset:13152
  v_mfma_f32_16x16x32_bf16 v[24:27], a[52:55], a[64:67], v[24:27]
  v_mfma_f32_16x16x32_bf16 v[28:31], a[52:55], a[68:71], v[28:31]
  ds_read_b128 a[24:27], v246 offset:3936
  v_mfma_f32_16x16x32_bf16 v[32:35], a[52:55], a[72:75], v[32:35]
  ds_read_b128 a[28:31], v246 offset:11616
  v_mfma_f32_16x16x32_bf16 v[36:39], a[52:55], a[76:79], v[36:39]
  v_mfma_f32_16x16x32_bf16 v[40:43], a[52:55], a[80:83], v[40:43]
  ds_read_b128 a[32:35], v246 offset:2400
  v_mfma_f32_16x16x32_bf16 v[44:47], a[52:55], a[84:87], v[44:47]
  ds_read_b128 a[36:39], v246 offset:10080
  v_mfma_f32_16x16x32_bf16 v[32:35], a[56:59], a[64:67], v[32:35]
  v_mfma_f32_16x16x32_bf16 v[36:39], a[56:59], a[68:71], v[36:39]
  ds_read_b128 a[40:43], v246 offset:864
  v_mfma_f32_16x16x32_bf16 v[40:43], a[56:59], a[72:75], v[40:43]
  ds_read_b128 a[44:47], v246 offset:8544
  v_mfma_f32_16x16x32_bf16 v[44:47], a[56:59], a[76:79], v[44:47]
  v_mfma_f32_16x16x32_bf16 v[40:43], a[60:63], a[64:67], v[40:43]
  v_mfma_f32_16x16x32_bf16 v[44:47], a[60:63], a[68:71], v[44:47]
  buffer_store_dwordx4 v[72:75], v14, s[36:39], s82 offen sc1
  buffer_store_dwordx4 v[76:79], v14, s[36:39], s82 offen offset:1024 sc1
  s_add_u32 s82, s82, 32768
  v_cvt_pk_bf16_f32 v64, v176, v177
  v_cvt_pk_bf16_f32 v65, v178, v179
  v_cvt_pk_bf16_f32 v66, v180, v181
  v_cvt_pk_bf16_f32 v67, v182, v183
  v_cvt_pk_bf16_f32 v68, v184, v185
  v_cvt_pk_bf16_f32 v69, v186, v187
  s_waitcnt lgkmcnt(12)
  v_mfma_f32_16x16x32_bf16 v[16:19], a[96:99], a[112:115], v[16:19]
  ds_read_b128 a[48:51], v245 offset:2560
  v_cvt_pk_bf16_f32 v70, v188, v189
  v_mfma_f32_16x16x32_bf16 v[20:23], a[96:99], a[116:119], v[20:23]
  ds_read_b128 a[52:55], v245 offset:6656
  v_mfma_f32_16x16x32_bf16 v[24:27], a[96:99], a[120:123], v[24:27]
  v_cvt_pk_bf16_f32 v71, v190, v191
  v_mfma_f32_16x16x32_bf16 v[28:31], a[96:99], a[124:127], v[28:31]
  ds_read_b128 a[56:59], v245 offset:10752
  v_mfma_f32_16x16x32_bf16 v[32:35], a[96:99], a[128:131], v[32:35]
  ds_read_b128 a[60:63], v245 offset:14848
  v_mfma_f32_16x16x32_bf16 v[36:39], a[96:99], a[132:135], v[36:39]
  v_mfma_f32_16x16x32_bf16 v[40:43], a[96:99], a[136:139], v[40:43]
  ds_read_b128 a[64:67], v246 offset:5568
  v_mfma_f32_16x16x32_bf16 v[44:47], a[96:99], a[140:143], v[44:47]
  ds_read_b128 a[68:71], v246 offset:13248
  v_mfma_f32_16x16x32_bf16 v[24:27], a[100:103], a[112:115], v[24:27]
  v_mfma_f32_16x16x32_bf16 v[28:31], a[100:103], a[116:119], v[28:31]
  ds_read_b128 a[72:75], v246 offset:4032
  v_mfma_f32_16x16x32_bf16 v[32:35], a[100:103], a[120:123], v[32:35]
  ds_read_b128 a[76:79], v246 offset:11712
  v_mfma_f32_16x16x32_bf16 v[36:39], a[100:103], a[124:127], v[36:39]
  v_mfma_f32_16x16x32_bf16 v[40:43], a[100:103], a[128:131], v[40:43]
  ds_read_b128 a[80:83], v246 offset:2496
  v_mfma_f32_16x16x32_bf16 v[44:47], a[100:103], a[132:135], v[44:47]
  ds_read_b128 a[84:87], v246 offset:10176
  v_mfma_f32_16x16x32_bf16 v[32:35], a[104:107], a[112:115], v[32:35]
  v_mfma_f32_16x16x32_bf16 v[36:39], a[104:107], a[116:119], v[36:39]
  ds_read_b128 a[88:91], v246 offset:960
  v_mfma_f32_16x16x32_bf16 v[40:43], a[104:107], a[120:123], v[40:43]
  ds_read_b128 a[92:95], v246 offset:8640
  v_mfma_f32_16x16x32_bf16 v[44:47], a[104:107], a[124:127], v[44:47]
  v_mfma_f32_16x16x32_bf16 v[40:43], a[108:111], a[112:115], v[40:43]
  v_mfma_f32_16x16x32_bf16 v[44:47], a[108:111], a[116:119], v[44:47]
  buffer_store_dwordx4 v[64:67], v14, s[36:39], s82 offen sc1
  buffer_store_dwordx4 v[68:71], v14, s[36:39], s82 offen offset:1024 sc1
  s_add_u32 s82, s82, 32768
  v_cvt_pk_bf16_f32 v72, v192, v193
  v_cvt_pk_bf16_f32 v73, v194, v195
  v_cvt_pk_bf16_f32 v74, v196, v197
  v_cvt_pk_bf16_f32 v75, v198, v199
  s_waitcnt lgkmcnt(12)
  v_mfma_f32_16x16x32_bf16 v[16:19], a[0:3], a[16:19], v[16:19]
  ds_read_b128 a[96:99], v245 offset:2816
  v_cvt_pk_bf16_f32 v76, v200, v201
  v_mfma_f32_16x16x32_bf16 v[20:23], a[0:3], a[20:23], v[20:23]
  ds_read_b128 a[100:103], v245 offset:6912
  v_mfma_f32_16x16x32_bf16 v[24:27], a[0:3], a[24:27], v[24:27]
  v_cvt_pk_bf16_f32 v77, v202, v203
  v_mfma_f32_16x16x32_bf16 v[28:31], a[0:3], a[28:31], v[28:31]
  ds_read_b128 a[104:107], v245 offset:11008
  v_mfma_f32_16x16x32_bf16 v[32:35], a[0:3], a[32:35], v[32:35]
  ds_read_b128 a[108:111], v245 offset:15104
  v_cvt_pk_bf16_f32 v78, v204, v205
  v_mfma_f32_16x16x32_bf16 v[36:39], a[0:3], a[36:39], v[36:39]
  v_mfma_f32_16x16x32_bf16 v[40:43], a[0:3], a[40:43], v[40:43]
  ds_read_b128 a[112:115], v246 offset:5664
  v_cvt_pk_bf16_f32 v79, v206, v207
  v_mfma_f32_16x16x32_bf16 v[44:47], a[0:3], a[44:47], v[44:47]
  ds_read_b128 a[116:119], v246 offset:13344
  v_mfma_f32_16x16x32_bf16 v[24:27], a[4:7], a[16:19], v[24:27]
  v_mfma_f32_16x16x32_bf16 v[28:31], a[4:7], a[20:23], v[28:31]
  ds_read_b128 a[120:123], v246 offset:4128
  v_mfma_f32_16x16x32_bf16 v[32:35], a[4:7], a[24:27], v[32:35]
  ds_read_b128 a[124:127], v246 offset:11808
  v_mfma_f32_16x16x32_bf16 v[36:39], a[4:7], a[28:31], v[36:39]
  v_mfma_f32_16x16x32_bf16 v[40:43], a[4:7], a[32:35], v[40:43]
  ds_read_b128 a[128:131], v246 offset:2592
  v_mfma_f32_16x16x32_bf16 v[44:47], a[4:7], a[36:39], v[44:47]
  ds_read_b128 a[132:135], v246 offset:10272
  v_mfma_f32_16x16x32_bf16 v[32:35], a[8:11], a[16:19], v[32:35]
  v_mfma_f32_16x16x32_bf16 v[36:39], a[8:11], a[20:23], v[36:39]
  ds_read_b128 a[136:139], v246 offset:1056
  v_mfma_f32_16x16x32_bf16 v[40:43], a[8:11], a[24:27], v[40:43]
  ds_read_b128 a[140:143], v246 offset:8736
  v_mfma_f32_16x16x32_bf16 v[44:47], a[8:11], a[28:31], v[44:47]
  v_mfma_f32_16x16x32_bf16 v[40:43], a[12:15], a[16:19], v[40:43]
  v_mfma_f32_16x16x32_bf16 v[44:47], a[12:15], a[20:23], v[44:47]
  buffer_store_dwordx4 v[72:75], v14, s[36:39], s82 offen sc1
  buffer_store_dwordx4 v[76:79], v14, s[36:39], s82 offen offset:1024 sc1
  s_add_u32 s82, s82, 32768
  v_cvt_pk_bf16_f32 v64, v208, v209
  v_cvt_pk_bf16_f32 v65, v210, v211
  s_waitcnt lgkmcnt(12)
  v_mfma_f32_16x16x32_bf16 v[16:19], a[48:51], a[64:67], v[16:19]
  ds_read_b128 a[0:3], v245 offset:3072
  v_cvt_pk_bf16_f32 v66, v212, v213
  v_mfma_f32_16x16x32_bf16 v[20:23], a[48:51], a[68:71], v[20:23]
  ds_read_b128 a[4:7], v245 offset:7168
  v_mfma_f32_16x16x32_bf16 v[24:27], a[48:51], a[72:75], v[24:27]
  v_cvt_pk_bf16_f32 v67, v214, v215
  v_mfma_f32_16x16x32_bf16 v[28:31], a[48:51], a[76:79], v[28:31]
  ds_read_b128 a[8:11], v245 offset:11264
  v_mfma_f32_16x16x32_bf16 v[32:35], a[48:51], a[80:83], v[32:35]
  ds_read_b128 a[12:15], v245 offset:15360
  v_mfma_f32_16x16x32_bf16 v[36:39], a[48:51], a[84:87], v[36:39]
  v_cvt_pk_bf16_f32 v68, v216, v217
  v_mfma_f32_16x16x32_bf16 v[40:43], a[48:51], a[88:91], v[40:43]
  ds_read_b128 a[16:19], v246 offset:5760
  v_mfma_f32_16x16x32_bf16 v[44:47], a[48:51], a[92:95], v[44:47]
  ds_read_b128 a[20:23], v246 offset:13440
  v_cvt_pk_bf16_f32 v69, v218, v219
  v_mfma_f32_16x16x32_bf16 v[24:27], a[52:55], a[64:67], v[24:27]
  v_mfma_f32_16x16x32_bf16 v[28:31], a[52:55], a[68:71], v[28:31]
  ds_read_b128 a[24:27], v246 offset:4224
  v_mfma_f32_16x16x32_bf16 v[32:35], a[52:55], a[72:75], v[32:35]
  ds_read_b128 a[28:31], v246 offset:11904
  v_cvt_pk_bf16_f32 v70, v220, v221
  v_mfma_f32_16x16x32_bf16 v[36:39], a[52:55], a[76:79], v[36:39]
  v_mfma_f32_16x16x32_bf16 v[40:43], a[52:55], a[80:83], v[40:43]
  ds_read_b128 a[32:35], v246 offset:2688
  v_cvt_pk_bf16_f32 v71, v222, v223
  v_mfma_f32_16x16x32_bf16 v[44:47], a[52:55], a[84:87], v[44:47]
  ds_read_b128 a[36:39], v246 offset:10368
  v_mfma_f32_16x16x32_bf16 v[32:35], a[56:59], a[64:67], v[32:35]
  v_mfma_f32_16x16x32_bf16 v[36:39], a[56:59], a[68:71], v[36:39]
  ds_read_b128 a[40:43], v246 offset:1152
  v_mfma_f32_16x16x32_bf16 v[40:43], a[56:59], a[72:75], v[40:43]
  ds_read_b128 a[44:47], v246 offset:8832
  v_mfma_f32_16x16x32_bf16 v[44:47], a[56:59], a[76:79], v[44:47]
  v_mfma_f32_16x16x32_bf16 v[40:43], a[60:63], a[64:67], v[40:43]
  v_mfma_f32_16x16x32_bf16 v[44:47], a[60:63], a[68:71], v[44:47]
  buffer_store_dwordx4 v[64:67], v14, s[36:39], s82 offen sc1
  buffer_store_dwordx4 v[68:71], v14, s[36:39], s82 offen offset:1024 sc1
  s_waitcnt lgkmcnt(12)
  v_mfma_f32_16x16x32_bf16 v[16:19], a[96:99], a[112:115], v[16:19]
  ds_read_b128 a[48:51], v245 offset:3328
  v_mfma_f32_16x16x32_bf16 v[20:23], a[96:99], a[116:119], v[20:23]
  ds_read_b128 a[52:55], v245 offset:7424
  v_mfma_f32_16x16x32_bf16 v[24:27], a[96:99], a[120:123], v[24:27]
  v_mfma_f32_16x16x32_bf16 v[28:31], a[96:99], a[124:127], v[28:31]
  ds_read_b128 a[56:59], v245 offset:11520
  v_mfma_f32_16x16x32_bf16 v[32:35], a[96:99], a[128:131], v[32:35]
  ds_read_b128 a[60:63], v245 offset:15616
  v_mfma_f32_16x16x32_bf16 v[36:39], a[96:99], a[132:135], v[36:39]
  v_mfma_f32_16x16x32_bf16 v[40:43], a[96:99], a[136:139], v[40:43]
  ds_read_b128 a[64:67], v246 offset:5856
  v_mfma_f32_16x16x32_bf16 v[44:47], a[96:99], a[140:143], v[44:47]
  ds_read_b128 a[68:71], v246 offset:13536
  v_mfma_f32_16x16x32_bf16 v[24:27], a[100:103], a[112:115], v[24:27]
  v_mfma_f32_16x16x32_bf16 v[28:31], a[100:103], a[116:119], v[28:31]
  ds_read_b128 a[72:75], v246 offset:4320
  v_mfma_f32_16x16x32_bf16 v[32:35], a[100:103], a[120:123], v[32:35]
  ds_read_b128 a[76:79], v246 offset:12000
  v_mfma_f32_16x16x32_bf16 v[36:39], a[100:103], a[124:127], v[36:39]
  v_mfma_f32_16x16x32_bf16 v[40:43], a[100:103], a[128:131], v[40:43]
  ds_read_b128 a[80:83], v246 offset:2784
  v_mfma_f32_16x16x32_bf16 v[44:47], a[100:103], a[132:135], v[44:47]
  ds_read_b128 a[84:87], v246 offset:10464
  v_mfma_f32_16x16x32_bf16 v[32:35], a[104:107], a[112:115], v[32:35]
  v_mfma_f32_16x16x32_bf16 v[36:39], a[104:107], a[116:119], v[36:39]
  ds_read_b128 a[88:91], v246 offset:1248
  v_mfma_f32_16x16x32_bf16 v[40:43], a[104:107], a[120:123], v[40:43]
  ds_read_b128 a[92:95], v246 offset:8928
  v_mfma_f32_16x16x32_bf16 v[44:47], a[104:107], a[124:127], v[44:47]
  v_mfma_f32_16x16x32_bf16 v[40:43], a[108:111], a[112:115], v[40:43]
  v_mfma_f32_16x16x32_bf16 v[44:47], a[108:111], a[116:119], v[44:47]
  s_waitcnt lgkmcnt(12)
  v_mfma_f32_16x16x32_bf16 v[16:19], a[0:3], a[16:19], v[16:19]
  ds_read_b128 a[96:99], v245 offset:3584
  v_mfma_f32_16x16x32_bf16 v[20:23], a[0:3], a[20:23], v[20:23]
  ds_read_b128 a[100:103], v245 offset:7680
  v_mfma_f32_16x16x32_bf16 v[24:27], a[0:3], a[24:27], v[24:27]
  v_mfma_f32_16x16x32_bf16 v[28:31], a[0:3], a[28:31], v[28:31]
  ds_read_b128 a[104:107], v245 offset:11776
  v_mfma_f32_16x16x32_bf16 v[32:35], a[0:3], a[32:35], v[32:35]
  ds_read_b128 a[108:111], v245 offset:15872
  v_mfma_f32_16x16x32_bf16 v[36:39], a[0:3], a[36:39], v[36:39]
  v_mfma_f32_16x16x32_bf16 v[40:43], a[0:3], a[40:43], v[40:43]
  ds_read_b128 a[112:115], v246 offset:5952
  v_mfma_f32_16x16x32_bf16 v[44:47], a[0:3], a[44:47], v[44:47]
  ds_read_b128 a[116:119], v246 offset:13632
  v_mfma_f32_16x16x32_bf16 v[24:27], a[4:7], a[16:19], v[24:27]
  v_mfma_f32_16x16x32_bf16 v[28:31], a[4:7], a[20:23], v[28:31]
  ds_read_b128 a[120:123], v246 offset:4416
  v_mfma_f32_16x16x32_bf16 v[32:35], a[4:7], a[24:27], v[32:35]
  ds_read_b128 a[124:127], v246 offset:12096
  v_mfma_f32_16x16x32_bf16 v[36:39], a[4:7], a[28:31], v[36:39]
  v_mfma_f32_16x16x32_bf16 v[40:43], a[4:7], a[32:35], v[40:43]
  ds_read_b128 a[128:131], v246 offset:2880
  v_mfma_f32_16x16x32_bf16 v[44:47], a[4:7], a[36:39], v[44:47]
  ds_read_b128 a[132:135], v246 offset:10560
  v_mfma_f32_16x16x32_bf16 v[32:35], a[8:11], a[16:19], v[32:35]
  v_mfma_f32_16x16x32_bf16 v[36:39], a[8:11], a[20:23], v[36:39]
  ds_read_b128 a[136:139], v246 offset:1344
  v_mfma_f32_16x16x32_bf16 v[40:43], a[8:11], a[24:27], v[40:43]
  ds_read_b128 a[140:143], v246 offset:9024
  v_mfma_f32_16x16x32_bf16 v[44:47], a[8:11], a[28:31], v[44:47]
  v_mfma_f32_16x16x32_bf16 v[40:43], a[12:15], a[16:19], v[40:43]
  v_mfma_f32_16x16x32_bf16 v[44:47], a[12:15], a[20:23], v[44:47]
  s_waitcnt lgkmcnt(12)
  v_mfma_f32_16x16x32_bf16 v[16:19], a[48:51], a[64:67], v[16:19]
  ds_read_b128 a[0:3], v245 offset:3840
  v_mfma_f32_16x16x32_bf16 v[20:23], a[48:51], a[68:71], v[20:23]
  ds_read_b128 a[4:7], v245 offset:7936
  v_mfma_f32_16x16x32_bf16 v[24:27], a[48:51], a[72:75], v[24:27]
  v_mfma_f32_16x16x32_bf16 v[28:31], a[48:51], a[76:79], v[28:31]
  ds_read_b128 a[8:11], v245 offset:12032
  v_mfma_f32_16x16x32_bf16 v[32:35], a[48:51], a[80:83], v[32:35]
  ds_read_b128 a[12:15], v245 offset:16128
  v_mfma_f32_16x16x32_bf16 v[36:39], a[48:51], a[84:87], v[36:39]
  v_mfma_f32_16x16x32_bf16 v[40:43], a[48:51], a[88:91], v[40:43]
  ds_read_b128 a[16:19], v246 offset:6048
  v_mfma_f32_16x16x32_bf16 v[44:47], a[48:51], a[92:95], v[44:47]
  ds_read_b128 a[20:23], v246 offset:13728
  v_mfma_f32_16x16x32_bf16 v[24:27], a[52:55], a[64:67], v[24:27]
  v_mfma_f32_16x16x32_bf16 v[28:31], a[52:55], a[68:71], v[28:31]
  ds_read_b128 a[24:27], v246 offset:4512
  v_mfma_f32_16x16x32_bf16 v[32:35], a[52:55], a[72:75], v[32:35]
  ds_read_b128 a[28:31], v246 offset:12192
  v_mfma_f32_16x16x32_bf16 v[36:39], a[52:55], a[76:79], v[36:39]
  v_mfma_f32_16x16x32_bf16 v[40:43], a[52:55], a[80:83], v[40:43]
  ds_read_b128 a[32:35], v246 offset:2976
  v_mfma_f32_16x16x32_bf16 v[44:47], a[52:55], a[84:87], v[44:47]
  ds_read_b128 a[36:39], v246 offset:10656
  v_mfma_f32_16x16x32_bf16 v[32:35], a[56:59], a[64:67], v[32:35]
  v_mfma_f32_16x16x32_bf16 v[36:39], a[56:59], a[68:71], v[36:39]
  ds_read_b128 a[40:43], v246 offset:1440
  v_mfma_f32_16x16x32_bf16 v[40:43], a[56:59], a[72:75], v[40:43]
  ds_read_b128 a[44:47], v246 offset:9120
  v_mfma_f32_16x16x32_bf16 v[44:47], a[56:59], a[76:79], v[44:47]
  v_mfma_f32_16x16x32_bf16 v[40:43], a[60:63], a[64:67], v[40:43]
  v_mfma_f32_16x16x32_bf16 v[44:47], a[60:63], a[68:71], v[44:47]
  s_waitcnt lgkmcnt(12)
  v_mfma_f32_16x16x32_bf16 v[16:19], a[96:99], a[112:115], v[16:19]
  v_mfma_f32_16x16x32_bf16 v[20:23], a[96:99], a[116:119], v[20:23]
  v_mfma_f32_16x16x32_bf16 v[24:27], a[96:99], a[120:123], v[24:27]
  v_mfma_f32_16x16x32_bf16 v[28:31], a[96:99], a[124:127], v[28:31]
  v_mfma_f32_16x16x32_bf16 v[32:35], a[96:99], a[128:131], v[32:35]
  v_mfma_f32_16x16x32_bf16 v[36:39], a[96:99], a[132:135], v[36:39]
  v_mfma_f32_16x16x32_bf16 v[40:43], a[96:99], a[136:139], v[40:43]
  v_mfma_f32_16x16x32_bf16 v[44:47], a[96:99], a[140:143], v[44:47]
  v_mfma_f32_16x16x32_bf16 v[24:27], a[100:103], a[112:115], v[24:27]
  v_mfma_f32_16x16x32_bf16 v[28:31], a[100:103], a[116:119], v[28:31]
  v_mfma_f32_16x16x32_bf16 v[32:35], a[100:103], a[120:123], v[32:35]
  v_mfma_f32_16x16x32_bf16 v[36:39], a[100:103], a[124:127], v[36:39]
  v_mfma_f32_16x16x32_bf16 v[40:43], a[100:103], a[128:131], v[40:43]
  v_mfma_f32_16x16x32_bf16 v[44:47], a[100:103], a[132:135], v[44:47]
  v_mfma_f32_16x16x32_bf16 v[32:35], a[104:107], a[112:115], v[32:35]
  v_mfma_f32_16x16x32_bf16 v[36:39], a[104:107], a[116:119], v[36:39]
  v_mfma_f32_16x16x32_bf16 v[40:43], a[104:107], a[120:123], v[40:43]
  v_mfma_f32_16x16x32_bf16 v[44:47], a[104:107], a[124:127], v[44:47]
  v_mfma_f32_16x16x32_bf16 v[40:43], a[108:111], a[112:115], v[40:43]
  v_mfma_f32_16x16x32_bf16 v[44:47], a[108:111], a[116:119], v[44:47]
  s_waitcnt lgkmcnt(0)
  v_mfma_f32_16x16x32_bf16 v[16:19], a[0:3], a[16:19], v[16:19]
  v_mfma_f32_16x16x32_bf16 v[20:23], a[0:3], a[20:23], v[20:23]
  v_mfma_f32_16x16x32_bf16 v[24:27], a[0:3], a[24:27], v[24:27]
  v_mfma_f32_16x16x32_bf16 v[28:31], a[0:3], a[28:31], v[28:31]
  v_mfma_f32_16x16x32_bf16 v[32:35], a[0:3], a[32:35], v[32:35]
  v_mfma_f32_16x16x32_bf16 v[36:39], a[0:3], a[36:39], v[36:39]
  v_mfma_f32_16x16x32_bf16 v[40:43], a[0:3], a[40:43], v[40:43]
  v_mfma_f32_16x16x32_bf16 v[44:47], a[0:3], a[44:47], v[44:47]
  v_mfma_f32_16x16x32_bf16 v[24:27], a[4:7], a[16:19], v[24:27]
  v_mfma_f32_16x16x32_bf16 v[28:31], a[4:7], a[20:23], v[28:31]
  v_mfma_f32_16x16x32_bf16 v[32:35], a[4:7], a[24:27], v[32:35]
  v_mfma_f32_16x16x32_bf16 v[36:39], a[4:7], a[28:31], v[36:39]
  v_mfma_f32_16x16x32_bf16 v[40:43], a[4:7], a[32:35], v[40:43]
  v_mfma_f32_16x16x32_bf16 v[44:47], a[4:7], a[36:39], v[44:47]
  v_mfma_f32_16x16x32_bf16 v[32:35], a[8:11], a[16:19], v[32:35]
  v_mfma_f32_16x16x32_bf16 v[36:39], a[8:11], a[20:23], v[36:39]
  v_mfma_f32_16x16x32_bf16 v[40:43], a[8:11], a[24:27], v[40:43]
  v_mfma_f32_16x16x32_bf16 v[44:47], a[8:11], a[28:31], v[44:47]
  v_mfma_f32_16x16x32_bf16 v[40:43], a[12:15], a[16:19], v[40:43]
  v_mfma_f32_16x16x32_bf16 v[44:47], a[12:15], a[20:23], v[44:47]
  v_mov_b32 v4, v247
  v_mov_b32 v5, v248
  v_sub_u32 v2, 15, v4
  v_mul_u32_u24 v2, 96, v2
  v_lshlrev_b32 v3, 4, v5
  v_sub_u32 v2, v2, v3
  s_add_u32 s86, s87, 7728
  v_add_u32 v2, s86, v2
  ds_read_b128 v[48:51], v2 offset:4608
  ds_read_b128 v[52:55], v2 offset:3072
  ds_read_b128 v[56:59], v2 offset:1536
  ds_read_b128 v[60:63], v2 offset:0
  v_lshlrev_b32 v3, 6, v4
  v_lshl_add_u32 v3, v5, 4, v3
  s_lshl_b32 s82, s88, 12
  s_add_u32 s82, s82, 25165824
  s_waitcnt lgkmcnt(0)
  v_and_b32 v8, s98, v51
  v_lshlrev_b32 v9, 16, v51
  v_fma_f32 v8, v8, s90, v16
  v_fma_f32 v9, v9, s90, v20
  v_cvt_pk_bf16_f32 v224, v8, v9
  v_and_b32 v8, s98, v50
  v_lshlrev_b32 v9, 16, v50
  v_fma_f32 v8, v8, s90, v17
  v_fma_f32 v9, v9, s90, v21
  v_cvt_pk_bf16_f32 v225, v8, v9
  v_and_b32 v8, s98, v49
  v_lshlrev_b32 v9, 16, v49
  v_fma_f32 v8, v8, s90, v18
  v_fma_f32 v9, v9, s90, v22
  v_cvt_pk_bf16_f32 v226, v8, v9
  v_and_b32 v8, s98, v48
  v_lshlrev_b32 v9, 16, v48
  v_fma_f32 v8, v8, s90, v19
  v_fma_f32 v9, v9, s90, v23
  v_cvt_pk_bf16_f32 v227, v8, v9
  buffer_store_dwordx4 v[224:227], v3, s[36:39], s82 offen offset:0
  v_and_b32 v8, s98, v55
  v_lshlrev_b32 v9, 16, v55
  v_fma_f32 v8, v8, s90, v24
  v_fma_f32 v9, v9, s90, v28
  v_cvt_pk_bf16_f32 v228, v8, v9
  v_and_b32 v8, s98, v54
  v_lshlrev_b32 v9, 16, v54
  v_fma_f32 v8, v8, s90, v25
  v_fma_f32 v9, v9, s90, v29
  v_cvt_pk_bf16_f32 v229, v8, v9
  v_and_b32 v8, s98, v53
  v_lshlrev_b32 v9, 16, v53
  v_fma_f32 v8, v8, s90, v26
  v_fma_f32 v9, v9, s90, v30
  v_cvt_pk_bf16_f32 v230, v8, v9
  v_and_b32 v8, s98, v52
  v_lshlrev_b32 v9, 16, v52
  v_fma_f32 v8, v8, s90, v27
  v_fma_f32 v9, v9, s90, v31
  v_cvt_pk_bf16_f32 v231, v8, v9
  buffer_store_dwordx4 v[228:231], v3, s[36:39], s82 offen offset:1024
  v_and_b32 v8, s98, v59
  v_lshlrev_b32 v9, 16, v59
  v_fma_f32 v8, v8, s90, v32
  v_fma_f32 v9, v9, s90, v36
  v_cvt_pk_bf16_f32 v232, v8, v9
  v_and_b32 v8, s98, v58
  v_lshlrev_b32 v9, 16, v58
  v_fma_f32 v8, v8, s90, v33
  v_fma_f32 v9, v9, s90, v37
  v_cvt_pk_bf16_f32 v233, v8, v9
  v_and_b32 v8, s98, v57
  v_lshlrev_b32 v9, 16, v57
  v_fma_f32 v8, v8, s90, v34
  v_fma_f32 v9, v9, s90, v38
  v_cvt_pk_bf16_f32 v234, v8, v9
  v_and_b32 v8, s98, v56
  v_lshlrev_b32 v9, 16, v56
  v_fma_f32 v8, v8, s90, v35
  v_fma_f32 v9, v9, s90, v39
  v_cvt_pk_bf16_f32 v235, v8, v9
  buffer_store_dwordx4 v[232:235], v3, s[36:39], s82 offen offset:2048
  v_and_b32 v8, s98, v63
  v_lshlrev_b32 v9, 16, v63
  v_fma_f32 v8, v8, s90, v40
  v_fma_f32 v9, v9, s90, v44
  v_cvt_pk_bf16_f32 v236, v8, v9
  v_and_b32 v8, s98, v62
  v_lshlrev_b32 v9, 16, v62
  v_fma_f32 v8, v8, s90, v41
  v_fma_f32 v9, v9, s90, v45
  v_cvt_pk_bf16_f32 v237, v8, v9
  v_and_b32 v8, s98, v61
  v_lshlrev_b32 v9, 16, v61
  v_fma_f32 v8, v8, s90, v42
  v_fma_f32 v9, v9, s90, v46
  v_cvt_pk_bf16_f32 v238, v8, v9
  v_and_b32 v8, s98, v60
  v_lshlrev_b32 v9, 16, v60
  v_fma_f32 v8, v8, s90, v43
  v_fma_f32 v9, v9, s90, v47
  v_cvt_pk_bf16_f32 v239, v8, v9
  buffer_store_dwordx4 v[236:239], v3, s[36:39], s82 offen offset:3072
  s_branch K1_FIN
K1_PART_ONLY:
  s_lshl_b32 s82, s77, 1
  s_add_u32 s82, s82, s75
  s_mul_i32 s82, s82, 18
  s_add_u32 s82, s82, s76
  s_lshl_b32 s82, s82, 3
  s_add_u32 s82, s82, s78
  s_lshl_b32 s82, s82, 11
  v_lshlrev_b32 v14, 4, v1
  s_nop 7
  v_cvt_pk_bf16_f32 v64, v80, v81
  v_cvt_pk_bf16_f32 v65, v82, v83
  v_cvt_pk_bf16_f32 v66, v84, v85
  v_cvt_pk_bf16_f32 v67, v86, v87
  v_cvt_pk_bf16_f32 v68, v88, v89
  v_cvt_pk_bf16_f32 v69, v90, v91
  v_cvt_pk_bf16_f32 v70, v92, v93
  v_cvt_pk_bf16_f32 v71, v94, v95
  buffer_store_dwordx4 v[64:67], v14, s[36:39], s82 offen sc1
  buffer_store_dwordx4 v[68:71], v14, s[36:39], s82 offen offset:1024 sc1
  s_add_u32 s82, s82, 32768
  v_cvt_pk_bf16_f32 v72, v96, v97
  v_cvt_pk_bf16_f32 v73, v98, v99
  v_cvt_pk_bf16_f32 v74, v100, v101
  v_cvt_pk_bf16_f32 v75, v102, v103
  v_cvt_pk_bf16_f32 v76, v104, v105
  v_cvt_pk_bf16_f32 v77, v106, v107
  v_cvt_pk_bf16_f32 v78, v108, v109
  v_cvt_pk_bf16_f32 v79, v110, v111
  buffer_store_dwordx4 v[72:75], v14, s[36:39], s82 offen sc1
  buffer_store_dwordx4 v[76:79], v14, s[36:39], s82 offen offset:1024 sc1
  s_add_u32 s82, s82, 32768
  v_cvt_pk_bf16_f32 v64, v112, v113
  v_cvt_pk_bf16_f32 v65, v114, v115
  v_cvt_pk_bf16_f32 v66, v116, v117
  v_cvt_pk_bf16_f32 v67, v118, v119
  v_cvt_pk_bf16_f32 v68, v120, v121
  v_cvt_pk_bf16_f32 v69, v122, v123
  v_cvt_pk_bf16_f32 v70, v124, v125
  v_cvt_pk_bf16_f32 v71, v126, v127
  buffer_store_dwordx4 v[64:67], v14, s[36:39], s82 offen sc1
  buffer_store_dwordx4 v[68:71], v14, s[36:39], s82 offen offset:1024 sc1
  s_add_u32 s82, s82, 32768
  v_cvt_pk_bf16_f32 v72, v128, v129
  v_cvt_pk_bf16_f32 v73, v130, v131
  v_cvt_pk_bf16_f32 v74, v132, v133
  v_cvt_pk_bf16_f32 v75, v134, v135
  v_cvt_pk_bf16_f32 v76, v136, v137
  v_cvt_pk_bf16_f32 v77, v138, v139
  v_cvt_pk_bf16_f32 v78, v140, v141
  v_cvt_pk_bf16_f32 v79, v142, v143
  buffer_store_dwordx4 v[72:75], v14, s[36:39], s82 offen sc1
  buffer_store_dwordx4 v[76:79], v14, s[36:39], s82 offen offset:1024 sc1
  s_add_u32 s82, s82, 32768
  v_cvt_pk_bf16_f32 v64, v144, v145
  v_cvt_pk_bf16_f32 v65, v146, v147
  v_cvt_pk_bf16_f32 v66, v148, v149
  v_cvt_pk_bf16_f32 v67, v150, v151
  v_cvt_pk_bf16_f32 v68, v152, v153
  v_cvt_pk_bf16_f32 v69, v154, v155
  v_cvt_pk_bf16_f32 v70, v156, v157
  v_cvt_pk_bf16_f32 v71, v158, v159
  buffer_store_dwordx4 v[64:67], v14, s[36:39], s82 offen sc1
  buffer_store_dwordx4 v[68:71], v14, s[36:39], s82 offen offset:1024 sc1
  s_add_u32 s82, s82, 32768
  v_cvt_pk_bf16_f32 v72, v160, v161
  v_cvt_pk_bf16_f32 v73, v162, v163
  v_cvt_pk_bf16_f32 v74, v164, v165
  v_cvt_pk_bf16_f32 v75, v166, v167
  v_cvt_pk_bf16_f32 v76, v168, v169
  v_cvt_pk_bf16_f32 v77, v170, v171
  v_cvt_pk_bf16_f32 v78, v172, v173
  v_cvt_pk_bf16_f32 v79, v174, v175
  buffer_store_dwordx4 v[72:75], v14, s[36:39], s82 offen sc1
  buffer_store_dwordx4 v[76:79], v14, s[36:39], s82 offen offset:1024 sc1
  s_add_u32 s82, s82, 32768
  v_cvt_pk_bf16_f32 v64, v176, v177
  v_cvt_pk_bf16_f32 v65, v178, v179
  v_cvt_pk_bf16_f32 v66, v180, v181
  v_cvt_pk_bf16_f32 v67, v182, v183
  v_cvt_pk_bf16_f32 v68, v184, v185
  v_cvt_pk_bf16_f32 v69, v186, v187
  v_cvt_pk_bf16_f32 v70, v188, v189
  v_cvt_pk_bf16_f32 v71, v190, v191
  buffer_store_dwordx4 v[64:67], v14, s[36:39], s82 offen sc1
  buffer_store_dwordx4 v[68:71], v14, s[36:39], s82 offen offset:1024 sc1
  s_add_u32 s82, s82, 32768
  v_cvt_pk_bf16_f32 v72, v192, v193
  v_cvt_pk_bf16_f32 v73, v194, v195
  v_cvt_pk_bf16_f32 v74, v196, v197
  v_cvt_pk_bf16_f32 v75, v198, v199
  v_cvt_pk_bf16_f32 v76, v200, v201
  v_cvt_pk_bf16_f32 v77, v202, v203
  v_cvt_pk_bf16_f32 v78, v204, v205
  v_cvt_pk_bf16_f32 v79, v206, v207
  buffer_store_dwordx4 v[72:75], v14, s[36:39], s82 offen sc1
  buffer_store_dwordx4 v[76:79], v14, s[36:39], s82 offen offset:1024 sc1
  s_add_u32 s82, s82, 32768
  v_cvt_pk_bf16_f32 v64, v208, v209
  v_cvt_pk_bf16_f32 v65, v210, v211
  v_cvt_pk_bf16_f32 v66, v212, v213
  v_cvt_pk_bf16_f32 v67, v214, v215
  v_cvt_pk_bf16_f32 v68, v216, v217
  v_cvt_pk_bf16_f32 v69, v218, v219
  v_cvt_pk_bf16_f32 v70, v220, v221
  v_cvt_pk_bf16_f32 v71, v222, v223
  buffer_store_dwordx4 v[64:67], v14, s[36:39], s82 offen sc1
  buffer_store_dwordx4 v[68:71], v14, s[36:39], s82 offen offset:1024 sc1
K1_FIN:
K1_END:
  s_endpgm
.globl final_kernel
.p2align 8
.type final_kernel,@function
final_kernel:
  s_cmp_ge_u32 s2, 576
  s_cbranch_scc1 K2_END
  s_load_dwordx2 s[4:5], s[0:1], 0
  s_load_dwordx2 s[6:7], s[0:1], 72
  s_load_dwordx2 s[8:9], s[0:1], 88
  s_mul_i32 s20, s2, 7282
  s_lshr_b32 s20, s20, 16
  s_mul_i32 s21, s20, 9
  s_sub_u32 s21, s2, s21
  v_and_b32 v1, 63, v0
  v_lshrrev_b32 v2, 6, v0
  v_lshlrev_b32 v3, 4, v1
  v_readfirstlane_b32 s22, v2
  s_lshr_b32 s24, s22, 1
  s_and_b32 s23, s22, 1
  s_mul_i32 s25, s20, 18
  s_lshl_b32 s26, s21, 1
  s_add_u32 s25, s25, s26
  s_add_u32 s25, s25, s24
  s_lshl_b32 s25, s25, 14
  s_lshl_b32 s26, s23, 10
  s_add_u32 s25, s25, s26
  s_add_u32 s25, s25, 0
  v_lshrrev_b32 v4, 2, v1
  v_and_b32 v5, 3, v1
  s_lshl_b32 s27, s22, 4
  s_lshl_b32 s26, s21, 6
  s_add_u32 s26, s26, s27
  v_add_u32 v6, s26, v4
  v_lshlrev_b32 v6, 12, v6
  v_lshl_add_u32 v6, v5, 4, v6
  s_lshl_b32 s26, s20, 6
  s_add_u32 s26, s26, 25165824
  v_lshrrev_b32 v7, 3, v0
  s_lshl_b32 s28, s20, 5
  v_add_u32 v7, s28, v7
  v_and_b32 v9, 7, v0
  v_mul_u32_u24 v8, 1152, v7
  v_lshl_add_u32 v8, v9, 4, v8
  s_lshl_b32 s28, s21, 7
  v_add_u32 v8, s28, v8
  v_lshlrev_b32 v7, 3, v7
  v_add_u32 v7, 29360128, v7
  s_waitcnt lgkmcnt(0)
  s_mov_b32 s12, s8
  s_mov_b32 s13, s9
  s_mov_b32 s14, 268435456
  s_mov_b32 s15, 0x00020000
  s_mov_b32 s16, s4
  s_mov_b32 s17, s5
  s_mov_b32 s18, 2359296
  s_mov_b32 s19, 0x00020000
  s_mov_b32 s32, s6
  s_mov_b32 s33, s7
  s_mov_b32 s34, 2359296
  s_mov_b32 s35, 0x00020000
  buffer_load_dwordx4 v[16:19], v3, s[12:15], s25 offen
  s_add_u32 s25, s25, 2048
  buffer_load_dwordx4 v[20:23], v3, s[12:15], s25 offen
  s_add_u32 s25, s25, 2048
  buffer_load_dwordx4 v[24:27], v3, s[12:15], s25 offen
  s_add_u32 s25, s25, 2048
  buffer_load_dwordx4 v[28:31], v3, s[12:15], s25 offen
  s_add_u32 s25, s25, 2048
  buffer_load_dwordx4 v[32:35], v3, s[12:15], s25 offen
  s_add_u32 s25, s25, 2048
  buffer_load_dwordx4 v[36:39], v3, s[12:15], s25 offen
  s_add_u32 s25, s25, 2048
  buffer_load_dwordx4 v[40:43], v3, s[12:15], s25 offen
  s_add_u32 s25, s25, 2048
  buffer_load_dwordx4 v[44:47], v3, s[12:15], s25 offen
  buffer_load_dwordx4 v[48:51], v6, s[12:15], s26 offen
  buffer_load_dwordx4 v[52:55], v8, s[16:19], 0 offen
  buffer_load_dwordx2 v[56:57], v7, s[12:15], 0 offen
  s_mov_b32 s30, 0xffff0000
  s_lshl_b32 s26, s22, 10
  v_lshlrev_b32 v10, 6, v4
  v_lshl_add_u32 v10, v5, 4, v10
  v_add_u32 v10, s26, v10
  v_and_b32 v11, 15, v1
  v_lshrrev_b32 v12, 5, v1
  v_bfe_u32 v13, v1, 4, 1
  v_lshlrev_b32 v13, 5, v13
  v_and_b32 v14, 3, v11
  v_lshl_add_u32 v13, v14, 3, v13
  v_lshrrev_b32 v14, 2, v11
  v_lshl_add_u32 v14, v12, 2, v14
  v_lshl_add_u32 v13, v14, 6, v13
  v_add_u32 v13, s26, v13
  v_and_b32 v14, 31, v1
  v_mul_u32_u24 v14, 272, v14
  v_lshl_add_u32 v14, v12, 4, v14
  s_lshl_b32 s26, s22, 6
  s_add_u32 s26, s26, 4096
  v_add_u32 v14, s26, v14
  v_lshrrev_b32 v15, 3, v0
  v_mul_u32_u24 v15, 272, v15
  v_lshl_add_u32 v15, v9, 5, v15
  s_waitcnt vmcnt(10)
  v_lshlrev_b32 v64, 16, v16
  v_and_b32 v65, s30, v16
  v_lshlrev_b32 v66, 16, v17
  v_and_b32 v67, s30, v17
  v_lshlrev_b32 v68, 16, v18
  v_and_b32 v69, s30, v18
  v_lshlrev_b32 v70, 16, v19
  v_and_b32 v71, s30, v19
  s_waitcnt vmcnt(9)
  v_lshlrev_b32 v60, 16, v20
  v_and_b32 v61, s30, v20
  v_pk_add_f32 v[64:65], v[64:65], v[60:61]
  v_lshlrev_b32 v60, 16, v21
  v_and_b32 v61, s30, v21
  v_pk_add_f32 v[66:67], v[66:67], v[60:61]
  v_lshlrev_b32 v60, 16, v22
  v_and_b32 v61, s30, v22
  v_pk_add_f32 v[68:69], v[68:69], v[60:61]
  v_lshlrev_b32 v60, 16, v23
  v_and_b32 v61, s30, v23
  v_pk_add_f32 v[70:71], v[70:71], v[60:61]
  s_waitcnt vmcnt(8)
  v_lshlrev_b32 v60, 16, v24
  v_and_b32 v61, s30, v24
  v_pk_add_f32 v[64:65], v[64:65], v[60:61]
  v_lshlrev_b32 v60, 16, v25
  v_and_b32 v61, s30, v25
  v_pk_add_f32 v[66:67], v[66:67], v[60:61]
  v_lshlrev_b32 v60, 16, v26
  v_and_b32 v61, s30, v26
  v_pk_add_f32 v[68:69], v[68:69], v[60:61]
  v_lshlrev_b32 v60, 16, v27
  v_and_b32 v61, s30, v27
  v_pk_add_f32 v[70:71], v[70:71], v[60:61]
  s_waitcnt vmcnt(7)
  v_lshlrev_b32 v60, 16, v28
  v_and_b32 v61, s30, v28
  v_pk_add_f32 v[64:65], v[64:65], v[60:61]
  v_lshlrev_b32 v60, 16, v29
  v_and_b32 v61, s30, v29
  v_pk_add_f32 v[66:67], v[66:67], v[60:61]
  v_lshlrev_b32 v60, 16, v30
  v_and_b32 v61, s30, v30
  v_pk_add_f32 v[68:69], v[68:69], v[60:61]
  v_lshlrev_b32 v60, 16, v31
  v_and_b32 v61, s30, v31
  v_pk_add_f32 v[70:71], v[70:71], v[60:61]
  s_waitcnt vmcnt(6)
  v_lshlrev_b32 v60, 16, v32
  v_and_b32 v61, s30, v32
  v_pk_add_f32 v[64:65], v[64:65], v[60:61]
  v_lshlrev_b32 v60, 16, v33
  v_and_b32 v61, s30, v33
  v_pk_add_f32 v[66:67], v[66:67], v[60:61]
  v_lshlrev_b32 v60, 16, v34
  v_and_b32 v61, s30, v34
  v_pk_add_f32 v[68:69], v[68:69], v[60:61]
  v_lshlrev_b32 v60, 16, v35
  v_and_b32 v61, s30, v35
  v_pk_add_f32 v[70:71], v[70:71], v[60:61]
  s_waitcnt vmcnt(5)
  v_lshlrev_b32 v60, 16, v36
  v_and_b32 v61, s30, v36
  v_pk_add_f32 v[64:65], v[64:65], v[60:61]
  v_lshlrev_b32 v60, 16, v37
  v_and_b32 v61, s30, v37
  v_pk_add_f32 v[66:67], v[66:67], v[60:61]
  v_lshlrev_b32 v60, 16, v38
  v_and_b32 v61, s30, v38
  v_pk_add_f32 v[68:69], v[68:69], v[60:61]
  v_lshlrev_b32 v60, 16, v39
  v_and_b32 v61, s30, v39
  v_pk_add_f32 v[70:71], v[70:71], v[60:61]
  s_waitcnt vmcnt(4)
  v_lshlrev_b32 v60, 16, v40
  v_and_b32 v61, s30, v40
  v_pk_add_f32 v[64:65], v[64:65], v[60:61]
  v_lshlrev_b32 v60, 16, v41
  v_and_b32 v61, s30, v41
  v_pk_add_f32 v[66:67], v[66:67], v[60:61]
  v_lshlrev_b32 v60, 16, v42
  v_and_b32 v61, s30, v42
  v_pk_add_f32 v[68:69], v[68:69], v[60:61]
  v_lshlrev_b32 v60, 16, v43
  v_and_b32 v61, s30, v43
  v_pk_add_f32 v[70:71], v[70:71], v[60:61]
  s_waitcnt vmcnt(3)
  v_lshlrev_b32 v60, 16, v44
  v_and_b32 v61, s30, v44
  v_pk_add_f32 v[64:65], v[64:65], v[60:61]
  v_lshlrev_b32 v60, 16, v45
  v_and_b32 v61, s30, v45
  v_pk_add_f32 v[66:67], v[66:67], v[60:61]
  v_lshlrev_b32 v60, 16, v46
  v_and_b32 v61, s30, v46
  v_pk_add_f32 v[68:69], v[68:69], v[60:61]
  v_lshlrev_b32 v60, 16, v47
  v_and_b32 v61, s30, v47
  v_pk_add_f32 v[70:71], v[70:71], v[60:61]
  v_exp_f32 v16, v64
  v_exp_f32 v17, v65
  v_exp_f32 v18, v66
  v_exp_f32 v19, v67
  v_exp_f32 v20, v68
  v_exp_f32 v21, v69
  v_exp_f32 v22, v70
  v_exp_f32 v23, v71
  s_waitcnt vmcnt(2)
  ds_write_b128 v10, v[48:51]
  v_add_f32 v16, 1.0, v16
  v_add_f32 v17, 1.0, v17
  v_add_f32 v18, 1.0, v18
  v_add_f32 v19, 1.0, v19
  v_add_f32 v20, 1.0, v20
  v_add_f32 v21, 1.0, v21
  v_add_f32 v22, 1.0, v22
  v_add_f32 v23, 1.0, v23
  v_rcp_f32 v16, v16
  v_rcp_f32 v17, v17
  v_rcp_f32 v18, v18
  v_rcp_f32 v19, v19
  v_rcp_f32 v20, v20
  v_rcp_f32 v21, v21
  v_rcp_f32 v22, v22
  v_rcp_f32 v23, v23
  s_waitcnt lgkmcnt(0)
  ds_read_b64_tr_b16 v[32:33], v13 offset:0
  ds_read_b64_tr_b16 v[34:35], v13 offset:512
  v_mul_f32 v64, 0xbf317218, v64
  v_mul_f32 v65, 0xbf317218, v65
  v_mul_f32 v66, 0xbf317218, v66
  v_mul_f32 v67, 0xbf317218, v67
  v_mul_f32 v68, 0xbf317218, v68
  v_mul_f32 v69, 0xbf317218, v69
  v_mul_f32 v70, 0xbf317218, v70
  v_mul_f32 v71, 0xbf317218, v71
  v_mul_f32 v64, v64, v16
  v_mul_f32 v65, v65, v17
  v_mul_f32 v66, v66, v18
  v_mul_f32 v67, v67, v19
  v_mul_f32 v68, v68, v20
  v_mul_f32 v69, v69, v21
  v_mul_f32 v70, v70, v22
  v_mul_f32 v71, v71, v23
  s_waitcnt lgkmcnt(0)
  v_lshlrev_b32 v60, 16, v32
  v_and_b32 v61, s30, v32
  v_mul_f32 v64, v64, v60
  v_mul_f32 v65, v65, v61
  v_lshlrev_b32 v60, 16, v33
  v_and_b32 v61, s30, v33
  v_mul_f32 v66, v66, v60
  v_mul_f32 v67, v67, v61
  ds_write_b128 v14, v[64:67] offset:0
  v_lshlrev_b32 v60, 16, v34
  v_and_b32 v61, s30, v34
  v_mul_f32 v68, v68, v60
  v_mul_f32 v69, v69, v61
  v_lshlrev_b32 v60, 16, v35
  v_and_b32 v61, s30, v35
  v_mul_f32 v70, v70, v60
  v_mul_f32 v71, v71, v61
  ds_write_b128 v14, v[68:71] offset:32
  s_waitcnt vmcnt(0) lgkmcnt(0)
  s_barrier
  ds_read_b128 v[16:19], v15 offset:4096
  ds_read_b128 v[20:23], v15 offset:4112
  v_sub_f32 v56, 0, v56
  s_waitcnt lgkmcnt(0)
  v_lshlrev_b32 v60, 16, v52
  v_and_b32 v61, s30, v52
  v_add_f32 v58, v60, v56
  v_add_f32 v59, v61, v56
  v_mul_f32 v58, v58, v57
  v_mul_f32 v59, v59, v57
  v_fmac_f32 v60, v58, v16
  v_fmac_f32 v61, v59, v17
  v_cvt_pk_bf16_f32 v32, v60, v61
  v_lshlrev_b32 v60, 16, v53
  v_and_b32 v61, s30, v53
  v_add_f32 v58, v60, v56
  v_add_f32 v59, v61, v56
  v_mul_f32 v58, v58, v57
  v_mul_f32 v59, v59, v57
  v_fmac_f32 v60, v58, v18
  v_fmac_f32 v61, v59, v19
  v_cvt_pk_bf16_f32 v33, v60, v61
  v_lshlrev_b32 v60, 16, v54
  v_and_b32 v61, s30, v54
  v_add_f32 v58, v60, v56
  v_add_f32 v59, v61, v56
  v_mul_f32 v58, v58, v57
  v_mul_f32 v59, v59, v57
  v_fmac_f32 v60, v58, v20
  v_fmac_f32 v61, v59, v21
  v_cvt_pk_bf16_f32 v34, v60, v61
  v_lshlrev_b32 v60, 16, v55
  v_and_b32 v61, s30, v55
  v_add_f32 v58, v60, v56
  v_add_f32 v59, v61, v56
  v_mul_f32 v58, v58, v57
  v_mul_f32 v59, v59, v57
  v_fmac_f32 v60, v58, v22
  v_fmac_f32 v61, v59, v23
  v_cvt_pk_bf16_f32 v35, v60, v61
  buffer_store_dwordx4 v[32:35], v8, s[32:35], 0 offen
K2_END:
  s_endpgm
.section .rodata,"a"
.p2align 6
.amdhsa_kernel ffn_conv_kernel
  .amdhsa_next_free_vgpr 512
  .amdhsa_next_free_sgpr 100
  .amdhsa_accum_offset 256
  .amdhsa_group_segment_fixed_size 0
  .amdhsa_kernarg_size 96
  .amdhsa_user_sgpr_count 2
  .amdhsa_user_sgpr_kernarg_segment_ptr 1
  .amdhsa_system_sgpr_workgroup_id_x 1
.end_amdhsa_kernel
.text
.section .rodata,"a"
.p2align 6
.amdhsa_kernel final_kernel
  .amdhsa_next_free_vgpr 72
  .amdhsa_next_free_sgpr 40
  .amdhsa_accum_offset 72
  .amdhsa_group_segment_fixed_size 0
  .amdhsa_kernarg_size 96
  .amdhsa_user_sgpr_count 2
  .amdhsa_user_sgpr_kernarg_segment_ptr 1
  .amdhsa_system_sgpr_workgroup_id_x 1
.end_amdhsa_kernel
.text
```
